```python
import torch

def _softmax(x, axis=-1):
    return torch.softmax(x, dim=axis)
def _gelu(x):
    return torch.nn.functional.gelu(x, approximate="tanh")
def _silu(x):
    return torch.nn.functional.silu(x)
def _sigmoid(x):
    return torch.sigmoid(x)
def _layernorm(x, axis=-1, eps=1e-5):
    m = x.mean(dim=axis, keepdim=True)
    v = x.var(dim=axis, keepdim=True, unbiased=False)
    return (x - m) / torch.sqrt(v + eps)
def _scatter_add(tgt, idx, src, axis=0):
    return tgt.clone().index_add_(axis, idx, src)
def _segment_sum(src, seg, n):
    out = torch.zeros((n,) + src.shape[1:], dtype=src.dtype)
    return out.index_add_(0, seg, src)
def _pad(x, pw):
    flat = tuple(v for pair in reversed(pw) for v in pair)
    return torch.nn.functional.pad(x, flat)

kernel_name = 'recurrent_scan__mha_block_cached__dense_activation_relu__decode'

def setup_inputs():

    _w = (lambda a: (lambda t: t.to(torch.bfloat16) if t.is_floating_point() else t)(torch.as_tensor(a)))
    def _A_setup():
        B, Sq, D = 4, 1, 640
        H, Sk, Dh = 32, 4096, 192
        return {
            "x": _w((lambda *s: torch.randn(*s, dtype=torch.bfloat16) * 0.05)(B, Sq, D)),
            "k_cache": _w((lambda *s: torch.randn(*s, dtype=torch.bfloat16) * 1.6)(B, H, Sk, Dh)),
            "v_cache": _w((lambda *s: torch.randn(*s, dtype=torch.bfloat16) * 0.2)(B, H, Sk, Dh)),
            "wq": _w((lambda *s: torch.randn(*s, dtype=torch.bfloat16) * 1.6)(D, H * Dh) * (D ** -0.5)),
            "wo": _w((lambda *s: torch.randn(*s, dtype=torch.bfloat16) * 0.2)(H * Dh, D) * ((H * Dh) ** -0.5)),
        }
    _A_in = _A_setup()

    def _B_setup():
        B, S, D, Dff = 4, 1, 640, 1536
        return {
            "x": _w((lambda *s: torch.randn(*s, dtype=torch.bfloat16) * 0.05)(B, S, D)),
            "w1": _w((lambda *s: torch.randn(*s, dtype=torch.bfloat16) * 0.1)(D, Dff)),
            "w2": _w((lambda *s: torch.randn(*s, dtype=torch.bfloat16) * 0.1)(Dff, D)),
        }
    _B_in = _B_setup()

    return {
        "A_x": _A_in["x"],
        "A_k_cache": _A_in["k_cache"],
        "A_v_cache": _A_in["v_cache"],
        "A_wq": _A_in["wq"],
        "A_wo": _A_in["wo"],
        "B_x": _B_in["x"],
        "B_w1": _B_in["w1"],
        "B_w2": _B_in["w2"],
    }

def reference(A_x, A_k_cache, A_v_cache, A_wq, A_wo, B_x, B_w1, B_w2):
    def _A_ref(x, k_cache, v_cache, wq, wo):
        B, Sq, D = x.shape
        H, Dh = 32, 192
        q = (lambda x, *d: x.permute(*d))((x @ wq).reshape(B, Sq, H, Dh), 0, 2, 1, 3)
        scores = torch.einsum("bhqd,bhkd->bhqk", q, k_cache) * (Dh ** -0.5)
        p = _softmax(scores, axis=-1)
        o = torch.einsum("bhqk,bhkd->bhqd", p, v_cache)
        return (lambda x, *d: x.permute(*d))(o, 0, 2, 1, 3).reshape(B, Sq, H * Dh) @ wo

    def _B_ref(x, w1, w2):
        h = torch.einsum("bsd,df->bsf", x, w1)
        zero = torch.zeros_like(h)
        h = torch.maximum(h, zero)
        return torch.einsum("bsf,fd->bsd", h, w2)

    x = A_x
    xn = _layernorm(x, axis=-1)
    s = _A_ref(xn, A_k_cache, A_v_cache, A_wq, A_wo)
    g = _silu(_B_ref(xn, B_w1, B_w2))
    return x + s * g
```

```asm
; @launch grid=(256,1,1) block=(256,1,1) lds=82944
.amdgcn_target "amdgcn-amd-amdhsa--gfx950"
.text
.globl recurrent_scan__mha_block_cached__dense_activation_relu__decode_kernel
.p2align 8
.type recurrent_scan__mha_block_cached__dense_activation_relu__decode_kernel,@function
recurrent_scan__mha_block_cached__dense_activation_relu__decode_kernel:
  s_load_dwordx16 s[4:19], s[0:1], 0
  s_cmp_ge_u32 s2, 256
  s_cbranch_scc1 L_end
  s_load_dwordx2 s[20:21], s[0:1], 64
  s_load_dwordx2 s[24:25], s[0:1], 80
  v_lshrrev_b32 v9, 6, v0
  v_and_b32 v4, 63, v0
  v_readfirstlane_b32 s3, v9
  s_lshr_b32 s65, s2, 5
  s_add_u32 s66, s2, s65
  s_and_b32 s66, s66, 7
  s_lshl_b32 s66, s66, 5
  s_lshr_b32 s65, s2, 3
  s_or_b32 s84, s66, s65
  s_lshr_b32 s65, s84, 1
  s_and_b32 s66, s84, 1
  s_cmp_lt_u32 s65, 96
  s_movk_i32 s64, 3072
  s_cselect_b32 s64, 12288, s64
  s_cselect_b32 s67, 0, 96
  s_sub_u32 s67, s65, s67
  s_lshl_b32 s67, s67, 7
  s_mul_i32 s68, s66, 320
  s_mul_i32 s68, s68, s64
  s_add_u32 s67, s67, s68
  s_mul_i32 s69, s64, 319
  s_add_u32 s69, s69, 128
  v_lshrrev_b32 v9, 3, v4
  v_and_b32 v10, 7, v4
  v_and_b32 v7, 6, v9
  v_xor_b32 v7, v7, v10
  v_mul_lo_u32 v16, s64, v9
  v_lshl_add_u32 v16, v7, 4, v16
  v_lshlrev_b32 v18, 4, v4
  v_lshlrev_b32 v19, 2, v4
  s_mul_i32 s70, s3, 1280
  s_mul_i32 s76, s3, 80
  s_mul_i32 s76, s76, s64
  s_mul_i32 s72, s3, 10240
  s_lshl_b32 s73, s64, 3
  s_mov_b32 s46, 5120
  s_mov_b32 s47, 0x00020000
  s_mov_b32 s39, 0x00020000
  s_cmp_lt_u32 s84, 240
  s_cselect_b32 s38, s69, 0
  s_cmp_lt_u32 s65, 96
  s_cselect_b32 s58, 2080768, 0
  s_waitcnt lgkmcnt(0)
  s_cselect_b32 s36, s10, s16
  s_cselect_b32 s37, s11, s17
  s_mov_b32 s44, s4
  s_mov_b32 s45, s5
  buffer_load_dwordx4 v[176:179], v18, s[44:47], s70 offen
  buffer_load_dword v180, v19, s[44:47], s70 offen offset:1024
  s_add_u32 s36, s36, s67
  s_addc_u32 s37, s37, 0
  s_mov_b32 m0, s72
  s_load_dword s63, s[24:25], 0
  buffer_load_dwordx4 v16, s[36:39], s76 offen nt lds
  s_add_u32 m0, m0, 1024
  s_add_u32 s76, s76, s73
  buffer_load_dwordx4 v16, s[36:39], s76 offen nt lds
  s_add_u32 m0, m0, 1024
  s_add_u32 s76, s76, s73
  buffer_load_dwordx4 v16, s[36:39], s76 offen nt lds
  s_add_u32 m0, m0, 1024
  s_add_u32 s76, s76, s73
  buffer_load_dwordx4 v16, s[36:39], s76 offen nt lds
  s_add_u32 m0, m0, 1024
  s_add_u32 s76, s76, s73
  buffer_load_dwordx4 v16, s[36:39], s76 offen nt lds
  s_add_u32 m0, m0, 1024
  s_add_u32 s76, s76, s73
  buffer_load_dwordx4 v16, s[36:39], s76 offen nt lds
  s_add_u32 m0, m0, 1024
  s_add_u32 s76, s76, s73
  buffer_load_dwordx4 v16, s[36:39], s76 offen nt lds
  s_add_u32 m0, m0, 1024
  s_add_u32 s76, s76, s73
  buffer_load_dwordx4 v16, s[36:39], s76 offen nt lds
  s_add_u32 m0, m0, 1024
  s_add_u32 s76, s76, s73
  buffer_load_dwordx4 v16, s[36:39], s76 offen nt lds
  s_add_u32 m0, m0, 1024
  s_add_u32 s76, s76, s73
  buffer_load_dwordx4 v16, s[36:39], s76 offen nt lds
  v_mul_u32_u24 v1, 384, v9
  v_lshl_add_u32 v1, v10, 4, v1
  s_mov_b32 s52, s20
  s_mov_b32 s53, s21
  s_and_b32 s65, s2, 7
  s_lshl_b32 s65, s65, 2
  s_lshr_b32 s65, 1460888608, s65
  s_and_b32 s65, s65, 7
  s_andn2_b32 s21, s2, 7
  s_or_b32 s21, s21, s65
  s_and_b32 s65, s21, 7
  s_lshl_b32 s65, s65, 3
  s_lshr_b32 s67, s21, 5
  s_add_u32 s65, s65, s67
  s_bfe_u32 s91, s21, 0x20003
  s_lshl_b32 s65, s65, 10
  s_add_u32 s65, s65, 1
  s_mul_hi_u32 s65, s65, 0xaaaaaaab
  s_lshr_b32 s89, s65, 1
  s_lshl_b32 s65, s91, 2
  s_add_u32 s65, s65, s89
  s_mul_i32 s67, s3, 3
  s_sub_u32 s88, s65, s67
  s_bitcmp1_b32 s91, 0
  s_cselect_b32 s67, -4, 4
  s_add_u32 s22, s88, s67
  s_mov_b32 s28, s6
  s_mov_b32 s29, s7
  s_mov_b32 s30, 201326592
  s_mov_b32 s31, 0x00020000
  s_mov_b32 s78, s3
  s_add_u32 s65, s65, s3
  s_mul_i32 s60, s65, 6144
  s_mov_b32 s48, s24
  s_mov_b32 s49, s25
  s_mov_b32 s50, 2080768
  s_mov_b32 s51, 0x00020000
  s_mov_b32 s56, s24
  s_mov_b32 s57, s25
  s_mov_b32 s59, 0x00020000
  s_lshl_b32 s65, s3, 8
  s_add_u32 s65, s65, s84
  s_cmp_eq_u32 s65, 1023
  s_cbranch_scc1 L_probe
L_probed:
  s_waitcnt vmcnt(10)
  v_lshlrev_b32 v184, 16, v176
  v_and_b32 v185, 0xffff0000, v176
  v_lshlrev_b32 v186, 16, v177
  v_and_b32 v187, 0xffff0000, v177
  v_lshlrev_b32 v188, 16, v178
  v_and_b32 v189, 0xffff0000, v178
  v_lshlrev_b32 v190, 16, v179
  v_and_b32 v191, 0xffff0000, v179
  v_lshlrev_b32 v192, 16, v180
  v_and_b32 v193, 0xffff0000, v180
  v_add_f32 v196, v184, v185
  v_add_f32 v196, v196, v186
  v_add_f32 v196, v196, v187
  v_add_f32 v196, v196, v188
  v_add_f32 v196, v196, v189
  v_add_f32 v196, v196, v190
  v_add_f32 v196, v196, v191
  v_add_f32 v196, v196, v192
  v_add_f32 v196, v196, v193
  s_nop 1
  v_add_f32_dpp v196, v196, v196 quad_perm:[1,0,3,2] row_mask:0xf bank_mask:0xf
  s_nop 1
  v_add_f32_dpp v196, v196, v196 quad_perm:[2,3,0,1] row_mask:0xf bank_mask:0xf
  s_nop 1
  v_add_f32_dpp v196, v196, v196 row_half_mirror row_mask:0xf bank_mask:0xf
  s_nop 1
  v_add_f32_dpp v196, v196, v196 row_mirror row_mask:0xf bank_mask:0xf
  v_mov_b32 v197, v196
  s_nop 1
  v_permlane16_swap_b32 v196, v197
  s_nop 0
  v_add_f32 v196, v196, v197
  v_mov_b32 v197, v196
  s_nop 1
  v_permlane32_swap_b32 v196, v197
  s_nop 0
  v_add_f32 v196, v196, v197
  v_mul_f32 v198, 0x3acccccd, v196
  v_sub_f32 v200, v184, v198
  v_sub_f32 v201, v185, v198
  v_sub_f32 v202, v186, v198
  v_sub_f32 v203, v187, v198
  v_sub_f32 v204, v188, v198
  v_sub_f32 v205, v189, v198
  v_sub_f32 v206, v190, v198
  v_sub_f32 v207, v191, v198
  v_sub_f32 v208, v192, v198
  v_sub_f32 v209, v193, v198
  v_mul_f32 v196, v200, v200
  v_fmac_f32 v196, v201, v201
  v_fmac_f32 v196, v202, v202
  v_fmac_f32 v196, v203, v203
  v_fmac_f32 v196, v204, v204
  v_fmac_f32 v196, v205, v205
  v_fmac_f32 v196, v206, v206
  v_fmac_f32 v196, v207, v207
  v_fmac_f32 v196, v208, v208
  v_fmac_f32 v196, v209, v209
  s_nop 1
  v_add_f32_dpp v196, v196, v196 quad_perm:[1,0,3,2] row_mask:0xf bank_mask:0xf
  s_nop 1
  v_add_f32_dpp v196, v196, v196 quad_perm:[2,3,0,1] row_mask:0xf bank_mask:0xf
  s_nop 1
  v_add_f32_dpp v196, v196, v196 row_half_mirror row_mask:0xf bank_mask:0xf
  s_nop 1
  v_add_f32_dpp v196, v196, v196 row_mirror row_mask:0xf bank_mask:0xf
  v_mov_b32 v197, v196
  s_nop 1
  v_permlane16_swap_b32 v196, v197
  s_nop 0
  v_add_f32 v196, v196, v197
  v_mov_b32 v197, v196
  s_nop 1
  v_permlane32_swap_b32 v196, v197
  s_nop 0
  v_add_f32 v196, v196, v197
  buffer_load_dwordx4 v[80:83], v1, s[28:31], s60 offen offset:0 nt
  buffer_load_dwordx4 v[84:87], v1, s[28:31], s60 offen offset:128 nt
  buffer_load_dwordx4 v[88:91], v1, s[28:31], s60 offen offset:256 nt
  v_mul_f32 v196, 0x3acccccd, v196
  v_cvt_pk_bf16_f32 v197, v198, v196
  v_lshlrev_b32 v198, 16, v197
  v_and_b32 v196, 0xffff0000, v197
  v_add_f32 v196, 0x3727c5ac, v196
  v_cvt_pk_bf16_f32 v197, v196, v196
  v_and_b32 v196, 0xffff0000, v197
  v_sqrt_f32 v196, v196
  v_sub_f32 v200, v184, v198
  v_sub_f32 v201, v185, v198
  v_sub_f32 v202, v186, v198
  v_sub_f32 v203, v187, v198
  v_sub_f32 v204, v188, v198
  v_sub_f32 v205, v189, v198
  v_sub_f32 v206, v190, v198
  v_sub_f32 v207, v191, v198
  v_sub_f32 v208, v192, v198
  v_sub_f32 v209, v193, v198
  v_cvt_pk_bf16_f32 v197, v196, v196
  v_and_b32 v196, 0xffff0000, v197
  v_rcp_f32 v197, v196
  v_cvt_pk_bf16_f32 v176, v200, v201
  v_cvt_pk_bf16_f32 v177, v202, v203
  v_cvt_pk_bf16_f32 v178, v204, v205
  v_cvt_pk_bf16_f32 v179, v206, v207
  v_cvt_pk_bf16_f32 v180, v208, v209
  v_lshlrev_b32 v200, 16, v176
  v_and_b32 v201, 0xffff0000, v176
  v_lshlrev_b32 v202, 16, v177
  v_and_b32 v203, 0xffff0000, v177
  v_lshlrev_b32 v204, 16, v178
  v_and_b32 v205, 0xffff0000, v178
  v_lshlrev_b32 v206, 16, v179
  v_and_b32 v207, 0xffff0000, v179
  v_lshlrev_b32 v208, 16, v180
  v_and_b32 v209, 0xffff0000, v180
  v_mul_f32 v184, v200, v197
  v_mul_f32 v185, v201, v197
  v_mul_f32 v186, v202, v197
  v_mul_f32 v187, v203, v197
  v_mul_f32 v188, v204, v197
  v_mul_f32 v189, v205, v197
  v_mul_f32 v190, v206, v197
  v_mul_f32 v191, v207, v197
  v_mul_f32 v192, v208, v197
  v_mul_f32 v193, v209, v197
  v_fma_f32 v200, -v184, v196, v200
  v_fma_f32 v201, -v185, v196, v201
  v_fma_f32 v202, -v186, v196, v202
  v_fma_f32 v203, -v187, v196, v203
  v_fma_f32 v204, -v188, v196, v204
  v_fma_f32 v205, -v189, v196, v205
  v_fma_f32 v206, -v190, v196, v206
  v_fma_f32 v207, -v191, v196, v207
  v_fma_f32 v208, -v192, v196, v208
  v_fma_f32 v209, -v193, v196, v209
  v_fmac_f32 v184, v200, v197
  v_fmac_f32 v185, v201, v197
  v_fmac_f32 v186, v202, v197
  v_fmac_f32 v187, v203, v197
  v_fmac_f32 v188, v204, v197
  v_fmac_f32 v189, v205, v197
  v_fmac_f32 v190, v206, v197
  v_fmac_f32 v191, v207, v197
  v_fmac_f32 v192, v208, v197
  v_fmac_f32 v193, v209, v197
  v_cvt_pk_bf16_f32 v176, v184, v185
  v_cvt_pk_bf16_f32 v177, v186, v187
  v_cvt_pk_bf16_f32 v178, v188, v189
  v_cvt_pk_bf16_f32 v179, v190, v191
  v_cvt_pk_bf16_f32 v180, v192, v193
  s_mul_i32 s70, s3, 1344
  s_add_u32 s70, s70, 49152
  v_lshrrev_b32 v7, 2, v4
  v_lshl_add_u32 v18, v7, 6, s70
  v_and_b32 v8, 1, v4
  v_lshl_add_u32 v18, v8, 5, v18
  v_and_b32 v7, 2, v4
  v_lshl_add_u32 v18, v7, 2, v18
  v_lshrrev_b32 v7, 4, v4
  v_lshl_add_u32 v19, v7, 6, s70
  v_lshl_add_u32 v19, v8, 2, v19
  v_and_b32 v7, 6, v4
  v_lshl_add_u32 v19, v7, 3, v19
  v_and_b32 v7, 8, v4
  v_add_u32 v19, v7, v19
  ds_write2_b64 v18, v[176:177], v[178:179] offset0:0 offset1:2
  ds_write_b32 v19, v180 offset:1024
  buffer_load_dwordx4 v[92:95], v1, s[28:31], s60 offen offset:3072 nt
  buffer_load_dwordx4 v[96:99], v1, s[28:31], s60 offen offset:3200 nt
  buffer_load_dwordx4 v[100:103], v1, s[28:31], s60 offen offset:3328 nt
  s_add_u32 s78, s78, 4
  s_lshl_b32 s60, s78, 2
  s_add_u32 s60, s60, s88
  s_mul_i32 s60, s60, 6144
  v_lshrrev_b32 v9, 4, v4
  v_bfe_u32 v10, v4, 2, 2
  v_lshl_add_u32 v7, v9, 2, v10
  v_bfe_u32 v8, v7, 1, 2
  v_xor_b32 v8, s3, v8
  v_lshlrev_b32 v8, 5, v8
  v_lshl_add_u32 v8, v7, 7, v8
  v_and_b32 v10, 3, v4
  v_lshl_add_u32 v18, v10, 3, v8
  v_mul_u32_u24 v19, 1344, v10
  v_lshl_add_u32 v19, v9, 4, v19
  s_mul_i32 s70, s66, 640
  s_add_u32 s70, s70, 49152
  v_add_u32 v19, s70, v19
  v_lshlrev_b32 v228, 6, v10
  v_lshl_add_u32 v228, v9, 4, v228
  s_mul_i32 s67, s84, 43691
  s_lshr_b32 s67, s67, 18
  s_mul_i32 s68, s67, 6
  s_sub_u32 s68, s84, s68
  s_mul_i32 s68, s68, 256
  s_mul_i32 s70, s67, 6144
  s_add_u32 s70, s70, 262144
  s_mul_i32 s71, s3, 1536
  s_add_u32 s70, s70, s71
  s_add_u32 s70, s70, s68
  v_add_u32 v228, s70, v228
  s_waitcnt vmcnt(6) lgkmcnt(0)
  s_add_u32 s62, s63, 0x11111111
  s_bfe_u32 s80, s62, 262144
  s_bfe_u32 s81, s62, 262148
  s_bfe_u32 s82, s62, 262152
  s_bfe_u32 s83, s62, 262156
  s_barrier
  ds_read_b64_tr_b16 v[128:129], v18 offset:0
  ds_read_b64_tr_b16 v[130:131], v18 offset:2048
  ds_read_b128 v[168:171], v19 offset:0
  ds_read_b64_tr_b16 v[132:133], v18 offset:4096
  ds_read_b64_tr_b16 v[134:135], v18 offset:6144
  ds_read_b128 v[172:175], v19 offset:64
  ds_read_b64_tr_b16 v[136:137], v18 offset:8192
  ds_read_b64_tr_b16 v[138:139], v18 offset:10240
  ds_read_b128 v[176:179], v19 offset:128
  ds_read_b64_tr_b16 v[140:141], v18 offset:12288
  ds_read_b64_tr_b16 v[142:143], v18 offset:14336
  ds_read_b128 v[180:183], v19 offset:192
  ds_read_b64_tr_b16 v[144:145], v18 offset:16384
  ds_read_b64_tr_b16 v[146:147], v18 offset:18432
  ds_read_b128 v[184:187], v19 offset:256
  s_waitcnt lgkmcnt(12)
  v_mfma_f32_16x16x32_bf16 v[224:227], v[128:131], v[168:171], 0
  ds_read_b64_tr_b16 v[148:149], v18 offset:20480
  ds_read_b64_tr_b16 v[150:151], v18 offset:22528
  ds_read_b128 v[188:191], v19 offset:320
  s_waitcnt lgkmcnt(12)
  v_mfma_f32_16x16x32_bf16 v[224:227], v[132:135], v[172:175], v[224:227]
  ds_read_b64_tr_b16 v[152:153], v18 offset:24576
  ds_read_b64_tr_b16 v[154:155], v18 offset:26624
  ds_read_b128 v[192:195], v19 offset:384
  s_waitcnt lgkmcnt(12)
  v_mfma_f32_16x16x32_bf16 v[224:227], v[136:139], v[176:179], v[224:227]
  ds_read_b64_tr_b16 v[156:157], v18 offset:28672
  ds_read_b64_tr_b16 v[158:159], v18 offset:30720
  ds_read_b128 v[196:199], v19 offset:448
  s_waitcnt lgkmcnt(12)
  v_mfma_f32_16x16x32_bf16 v[224:227], v[140:143], v[180:183], v[224:227]
  ds_read_b64_tr_b16 v[160:161], v18 offset:32768
  ds_read_b64_tr_b16 v[162:163], v18 offset:34816
  ds_read_b128 v[200:203], v19 offset:512
  s_waitcnt lgkmcnt(12)
  v_mfma_f32_16x16x32_bf16 v[224:227], v[144:147], v[184:187], v[224:227]
  ds_read_b64_tr_b16 v[164:165], v18 offset:36864
  ds_read_b64_tr_b16 v[166:167], v18 offset:38912
  ds_read_b128 v[204:207], v19 offset:576
  s_waitcnt lgkmcnt(12)
  v_mfma_f32_16x16x32_bf16 v[224:227], v[148:151], v[188:191], v[224:227]
  s_waitcnt lgkmcnt(9)
  v_mfma_f32_16x16x32_bf16 v[224:227], v[152:155], v[192:195], v[224:227]
  s_waitcnt lgkmcnt(6)
  v_mfma_f32_16x16x32_bf16 v[224:227], v[156:159], v[196:199], v[224:227]
  s_waitcnt lgkmcnt(3)
  v_mfma_f32_16x16x32_bf16 v[224:227], v[160:163], v[200:203], v[224:227]
  s_waitcnt lgkmcnt(0)
  v_mfma_f32_16x16x32_bf16 v[224:227], v[164:167], v[204:207], v[224:227]
  v_mov_b32 v17, s62
  s_nop 6
  v_and_or_b32 v224, v224, -16, s80
  v_and_or_b32 v225, v225, -16, s81
  v_and_or_b32 v226, v226, -16, s82
  v_and_or_b32 v227, v227, -16, s83
  s_mov_b32 exec_lo, 0x000f000f
  s_mov_b32 exec_hi, 0x000f000f
  buffer_store_dwordx4 v[224:227], v228, s[56:59], 0 offen sc1
  s_mov_b64 exec, -1
  s_waitcnt vmcnt(5)
  buffer_load_dwordx4 v[104:107], v1, s[28:31], s60 offen offset:0 nt
  s_and_b32 s66, s89, 255
  s_cmp_lg_u32 s66, 0
  s_cselect_b32 s67, 4, 0
  s_lshr_b32 s65, s89, 8
  s_lshl_b32 s65, s65, 3
  s_add_u32 s65, s65, s91
  s_add_u32 s20, s65, s67
  s_add_u32 s65, s65, 8
  s_waitcnt vmcnt(5)
  buffer_load_dwordx4 v[108:111], v1, s[28:31], s60 offen offset:128 nt
  s_lshl_b32 s65, s65, 10
  s_or_b32 s20, s20, s65
  s_cmp_eq_u32 s91, 3
  s_cselect_b32 s65, 5, 4
  s_cmp_eq_u32 s3, 0
  s_cselect_b32 s65, s91, s65
  s_add_u32 s65, s65, 336
  s_add_u32 s89, s89, s65
  s_sub_u32 s65, 256, s66
  s_waitcnt vmcnt(5)
  buffer_load_dwordx4 v[112:115], v1, s[28:31], s60 offen offset:256 nt
  s_lshr_b32 s65, s65, 4
  s_lshr_b32 s65, 65280, s65
  s_and_b32 s65, s65, 1
  s_xor_b32 s91, s91, s65
  s_lshl_b32 s65, s91, 2
  s_add_u32 s65, s65, s3
  s_add_u32 s65, s65, s66
  s_waitcnt vmcnt(5)
  buffer_load_dwordx4 v[116:119], v1, s[28:31], s60 offen offset:3072 nt
  s_sub_u32 s65, 271, s65
  s_lshr_b32 s65, s65, 4
  s_lshl_b32 s91, s65, 2
  s_lshl_b32 s92, s21, 7
  s_add_u32 s92, s92, 65537
  s_mul_hi_u32 s92, s92, 0xaaaaaaab
  s_lshr_b32 s92, s92, 1
  s_waitcnt vmcnt(5)
  buffer_load_dwordx4 v[120:123], v1, s[28:31], s60 offen offset:3200 nt
  s_lshl_b32 s90, s21, 7
  s_add_u32 s90, s90, 65665
  s_mul_hi_u32 s90, s90, 0xaaaaaaab
  s_lshr_b32 s90, s90, 1
  s_sub_u32 s90, s90, 128
  s_sub_u32 s92, s92, s90
  s_add_u32 s65, s21, 512
  s_waitcnt vmcnt(5)
  buffer_load_dwordx4 v[124:127], v1, s[28:31], s60 offen offset:3328 nt
  s_mul_i32 s65, s65, 43691
  s_lshr_b32 s65, s65, 18
  s_mul_i32 s66, s65, 6
  s_max_u32 s101, s66, 512
  s_add_u32 s66, s66, 6
  s_sub_u32 s35, s66, s101
  s_mul_i32 s15, s35, 4
  s_add_u32 s78, s78, 4
  s_lshl_b32 s60, s78, 2
  s_add_u32 s60, s60, s88
  s_mul_i32 s60, s60, 6144
  s_waitcnt vmcnt(5)
  buffer_load_dwordx4 v[128:131], v1, s[28:31], s60 offen offset:0 nt
  s_cmp_eq_u32 s35, 6
  s_movk_i32 s100, 16384
  s_cselect_b32 s100, 10923, s100
  s_lshl_b32 s66, s65, 1
  s_add_u32 s66, s66, s21
  s_sub_u32 s67, 518, s35
  s_add_u32 s66, s66, s67
  s_lshl_b32 s66, s66, 20
  s_or_b32 s20, s20, s66
  s_waitcnt vmcnt(5)
  buffer_load_dwordx4 v[132:135], v1, s[28:31], s60 offen offset:128 nt
  s_sub_u32 s65, s65, 85
  s_mul_i32 s65, s65, 896
  s_add_u32 s74, s65, 1982464
  s_add_u32 s32, s24, s74
  s_addc_u32 s33, s25, 0
  s_sub_u32 s101, s101, 512
  v_mov_b32 v230, 70992
  s_and_b32 s65, s2, 7
  s_waitcnt vmcnt(5)
  buffer_load_dwordx4 v[136:139], v1, s[28:31], s60 offen offset:256 nt
  s_mul_i32 s65, s65, 4480
  s_add_u32 s17, s65, 2031616
  s_add_u32 s10, s24, s17
  s_addc_u32 s11, s25, 0
  v_mov_b32 v232, s17
  v_lshrrev_b32 v9, 4, v4
  v_bfe_u32 v10, v4, 1, 3
  v_xor_b32 v10, v10, v9
  s_waitcnt vmcnt(5)
  buffer_load_dwordx4 v[140:143], v1, s[28:31], s60 offen offset:3072 nt
  v_mul_u32_u24 v2, 1280, v9
  v_lshl_add_u32 v2, v10, 5, v2
  v_and_b32 v10, 1, v4
  v_lshl_add_u32 v2, v10, 4, v2
  v_xor_b32 v3, 128, v2
  s_bfe_u32 s65, s20, 458755
  s_and_b32 s66, s65, 31
  s_waitcnt vmcnt(5)
  buffer_load_dwordx4 v[144:147], v1, s[28:31], s60 offen offset:3200 nt
  s_lshr_b32 s65, s65, 5
  s_mul_i32 s66, s66, 6144
  s_add_u32 s66, s66, 262144
  s_lshl_b32 s65, s65, 6
  s_add_u32 s65, s65, s66
  s_add_u32 s67, s65, s71
  s_bfe_u32 s65, s20, 458765
  s_waitcnt vmcnt(5)
  buffer_load_dwordx4 v[148:151], v1, s[28:31], s60 offen offset:3328 nt
  s_and_b32 s66, s65, 31
  s_lshr_b32 s65, s65, 5
  s_mul_i32 s66, s66, 6144
  s_add_u32 s66, s66, 262144
  s_lshl_b32 s65, s65, 6
  s_add_u32 s65, s65, s66
  s_add_u32 s68, s65, s71
  s_add_u32 s78, s78, 4
  s_lshl_b32 s60, s78, 2
  s_add_u32 s60, s60, s88
  s_mul_i32 s60, s60, 6144
  s_waitcnt vmcnt(5)
  buffer_load_dwordx4 v[152:155], v1, s[28:31], s60 offen offset:0 nt
  s_bfe_u32 s65, s20, 458775
  s_and_b32 s66, s65, 31
  s_lshr_b32 s65, s65, 5
  s_mul_i32 s66, s66, 6144
  s_add_u32 s66, s66, 262144
  s_lshl_b32 s65, s65, 6
  s_add_u32 s65, s65, s66
  s_waitcnt vmcnt(5)
  buffer_load_dwordx4 v[156:159], v1, s[28:31], s60 offen offset:128 nt
  s_add_u32 s69, s65, s71
  v_lshrrev_b32 v9, 3, v4
  v_and_b32 v10, 7, v4
  v_lshlrev_b32 v43, 2, v9
  s_lshl_b32 s65, s3, 5
  s_add_u32 s65, s65, 57472
  v_add_u32 v39, s65, v43
  s_waitcnt vmcnt(5)
  buffer_load_dwordx4 v[160:163], v1, s[28:31], s60 offen offset:256 nt
  v_lshrrev_b32 v7, 2, v10
  v_lshl_add_u32 v38, v7, 1, v39
  v_lshlrev_b32 v42, 4, v10
  v_add_u32 v42, 54528, v42
  v_lshl_add_u32 v41, v10, 3, v9
  s_mul_i32 s65, s3, 768
  s_add_u32 s65, s65, 61568
  s_waitcnt vmcnt(5)
  buffer_load_dwordx4 v[164:167], v1, s[28:31], s60 offen offset:3072 nt
  v_lshl_add_u32 v41, v41, 2, s65
  v_and_b32 v40, 15, v4
  v_min_u32 v9, 2, v9
  v_lshrrev_b32 v7, 2, v10
  v_lshl_add_u32 v16, v9, 1, v7
  v_mul_u32_u24 v16, 256, v16
  v_mul_u32_u24 v7, 7, v7
  s_waitcnt vmcnt(5)
  buffer_load_dwordx4 v[168:171], v1, s[28:31], s60 offen offset:3200 nt
  v_xor_b32 v7, v7, v10
  v_lshl_add_u32 v16, v7, 4, v16
  v_lshlrev_b32 v18, 7, v9
  v_lshl_add_u32 v18, v7, 3, v18
  s_lshl_b32 s65, s3, 5
  v_add_u32 v18, s65, v18
  s_cmp_ge_u32 s84, 192
  s_cselect_b32 s58, 2080768, 0
  s_waitcnt vmcnt(5)
  buffer_load_dwordx4 v[172:175], v1, s[28:31], s60 offen offset:3328 nt
  s_cmp_ge_u32 s84, 240
  s_cselect_b32 s58, 0, s58
  s_mov_b32 s77, 1048576
  v_mov_b32 v56, 0
  v_mov_b32 v57, 0
  v_mov_b32 v58, 0
  v_mov_b32 v59, 0
  v_mov_b32 v60, 0
  s_add_u32 s78, s78, 4
  s_lshl_b32 s60, s78, 2
  s_add_u32 s60, s60, s88
  s_mul_i32 s60, s60, 6144
  s_waitcnt vmcnt(5)
  buffer_load_dwordx4 v[176:179], v1, s[28:31], s60 offen offset:0 nt
  v_mov_b32 v61, 0
  v_mov_b32 v62, 0
  v_mov_b32 v63, 0
  v_mov_b32 v64, 0
  v_mov_b32 v65, 0
  v_mov_b32 v66, 0
  v_mov_b32 v67, 0
  s_waitcnt vmcnt(5)
  buffer_load_dwordx4 v[180:183], v1, s[28:31], s60 offen offset:128 nt
  v_mov_b32 v68, 0
  v_mov_b32 v69, 0
  v_mov_b32 v70, 0
  v_mov_b32 v71, 0
  v_mov_b32 v72, 0
  v_mov_b32 v73, 0
  v_mov_b32 v74, 0
  s_waitcnt vmcnt(5)
  buffer_load_dwordx4 v[184:187], v1, s[28:31], s60 offen offset:256 nt
  v_mov_b32 v75, 0
  v_mov_b32 v76, 0
  v_mov_b32 v77, 0
  v_mov_b32 v78, 0
  v_mov_b32 v79, 0
  v_mov_b32 v5, 0xff7f0000
  v_mov_b32 v6, 0
  s_waitcnt vmcnt(5)
  buffer_load_dwordx4 v[188:191], v1, s[28:31], s60 offen offset:3072 nt
  s_mov_b32 s94, 0
  s_mov_b32 s93, s91
  s_mov_b32 s95, 0
  s_add_u32 s79, s3, 20
  s_waitcnt vmcnt(5)
  buffer_load_dwordx4 v[192:195], v1, s[28:31], s60 offen offset:3200 nt
  s_waitcnt vmcnt(5)
  buffer_load_dwordx4 v[196:199], v1, s[28:31], s60 offen offset:3328 nt
  s_add_u32 s78, s78, 4
  s_lshl_b32 s60, s78, 2
  s_add_u32 s60, s60, s88
  s_mul_i32 s60, s60, 6144
  s_cmp_lg_u32 s3, 3
  s_cbranch_scc1 L_noclr
  s_cmp_lg_u32 s21, s101
  s_cbranch_scc1 L_noclr0
  s_mov_b64 exec, 1
  buffer_store_dword v6, v6, s[48:51], s74 offen sc1
  s_mov_b64 exec, -1
L_noclr0:
  s_cmp_lg_u32 s84, 255
  s_cbranch_scc1 L_noclr
  v_mov_b32 v32, 0
  v_mov_b32 v33, v17
  v_mov_b32 v34, s14
  v_mov_b32 v35, v17
  v_mul_u32_u24 v7, 4480, v4
  s_mov_b32 s65, 2031616
  s_mov_b64 exec, 0xff
  buffer_store_dwordx4 v[32:35], v7, s[48:51], s65 offen sc1
  s_mov_b64 exec, -1
L_noclr:
  buffer_load_dwordx4 v[20:23], v16, s[48:51], s67 offen sc1
  buffer_load_dwordx4 v[24:27], v16, s[48:51], s68 offen sc1
  buffer_load_dwordx4 v[28:31], v16, s[48:51], s69 offen sc1
  s_waitcnt vmcnt(8)
  buffer_load_dwordx4 v[200:203], v1, s[28:31], s60 offen offset:0 nt
  s_waitcnt vmcnt(8)
  buffer_load_dwordx4 v[204:207], v1, s[28:31], s60 offen offset:128 nt
  s_waitcnt vmcnt(8)
  buffer_load_dwordx4 v[208:211], v1, s[28:31], s60 offen offset:256 nt
  s_waitcnt vmcnt(8)
  buffer_load_dwordx4 v[212:215], v1, s[28:31], s60 offen offset:3072 nt
  s_waitcnt vmcnt(8)
  buffer_load_dwordx4 v[216:219], v1, s[28:31], s60 offen offset:3200 nt
  s_waitcnt vmcnt(8)
  buffer_load_dwordx4 v[220:223], v1, s[28:31], s60 offen offset:3328 nt
  s_add_u32 s78, s78, 4
  s_lshl_b32 s60, s78, 2
  s_add_u32 s60, s60, s88
  s_mul_i32 s60, s60, 6144
  s_waitcnt vmcnt(6)
L_qchk:
  v_xor_b32 v7, s80, v20
  v_bitop3_b32 v7, v21, s81, v7 bitop3:0xbe
  v_bitop3_b32 v7, v22, s82, v7 bitop3:0xbe
  v_bitop3_b32 v7, v23, s83, v7 bitop3:0xbe
  v_bitop3_b32 v7, v24, s80, v7 bitop3:0xbe
  v_bitop3_b32 v7, v25, s81, v7 bitop3:0xbe
  v_bitop3_b32 v7, v26, s82, v7 bitop3:0xbe
  v_bitop3_b32 v7, v27, s83, v7 bitop3:0xbe
  v_bitop3_b32 v7, v28, s80, v7 bitop3:0xbe
  v_bitop3_b32 v7, v29, s81, v7 bitop3:0xbe
  v_bitop3_b32 v7, v30, s82, v7 bitop3:0xbe
  v_bitop3_b32 v7, v31, s83, v7 bitop3:0xbe
  v_and_b32 v7, 15, v7
  v_cmp_ne_u32 vcc, 0, v7
  s_nop 1
  s_cbranch_vccz L_qok
  s_sub_u32 s77, s77, 1
  s_cbranch_scc1 L_end
  buffer_load_dwordx4 v[20:23], v16, s[48:51], s67 offen sc1
  buffer_load_dwordx4 v[24:27], v16, s[48:51], s68 offen sc1
  buffer_load_dwordx4 v[28:31], v16, s[48:51], s69 offen sc1
  s_waitcnt vmcnt(0)
  s_branch L_qchk
L_qok:
  v_and_b32 v20, -16, v20
  v_and_b32 v21, -16, v21
  v_and_b32 v22, -16, v22
  v_and_b32 v23, -16, v23
  v_and_b32 v24, -16, v24
  v_and_b32 v25, -16, v25
  v_and_b32 v26, -16, v26
  v_and_b32 v27, -16, v27
  v_and_b32 v28, -16, v28
  v_and_b32 v29, -16, v29
  v_and_b32 v30, -16, v30
  v_and_b32 v31, -16, v31
  v_add_f32_dpp v20, v20, v20 row_half_mirror row_mask:0xf bank_mask:0xf
  v_add_f32_dpp v21, v21, v21 row_half_mirror row_mask:0xf bank_mask:0xf
  v_add_f32_dpp v22, v22, v22 row_half_mirror row_mask:0xf bank_mask:0xf
  v_add_f32_dpp v23, v23, v23 row_half_mirror row_mask:0xf bank_mask:0xf
  v_add_f32_dpp v24, v24, v24 row_half_mirror row_mask:0xf bank_mask:0xf
  v_add_f32_dpp v25, v25, v25 row_half_mirror row_mask:0xf bank_mask:0xf
  v_add_f32_dpp v26, v26, v26 row_half_mirror row_mask:0xf bank_mask:0xf
  v_add_f32_dpp v27, v27, v27 row_half_mirror row_mask:0xf bank_mask:0xf
  v_add_f32_dpp v28, v28, v28 row_half_mirror row_mask:0xf bank_mask:0xf
  v_add_f32_dpp v29, v29, v29 row_half_mirror row_mask:0xf bank_mask:0xf
  v_add_f32_dpp v30, v30, v30 row_half_mirror row_mask:0xf bank_mask:0xf
  v_add_f32_dpp v31, v31, v31 row_half_mirror row_mask:0xf bank_mask:0xf
  v_cvt_pk_bf16_f32 v20, v20, v21
  v_cvt_pk_bf16_f32 v21, v22, v23
  v_cvt_pk_bf16_f32 v24, v24, v25
  v_cvt_pk_bf16_f32 v25, v26, v27
  v_cvt_pk_bf16_f32 v28, v28, v29
  v_cvt_pk_bf16_f32 v29, v30, v31
  ds_write_b64 v18, v[20:21] offset:54528
  ds_write_b64 v18, v[24:25] offset:54912
  ds_write_b64 v18, v[28:29] offset:55296
  v_mov_b32 v9, 70784
  ds_write_b128 v9, v[56:59]
  s_waitcnt lgkmcnt(0)
  s_barrier
  ds_read_b128 v[44:47], v42 offset:0
  ds_read_b128 v[48:51], v42 offset:128
  ds_read_b128 v[52:55], v42 offset:256
  s_waitcnt lgkmcnt(0)
  v_mov_b32 v7, 0
  v_mov_b32 v8, 0
  v_dot2c_f32_bf16 v7, v80, v44
  v_dot2c_f32_bf16 v7, v81, v45
  v_dot2c_f32_bf16 v7, v82, v46
  v_dot2c_f32_bf16 v7, v83, v47
  v_dot2c_f32_bf16 v7, v84, v48
  v_dot2c_f32_bf16 v7, v85, v49
  v_dot2c_f32_bf16 v7, v86, v50
  v_dot2c_f32_bf16 v7, v87, v51
  v_dot2c_f32_bf16 v7, v88, v52
  v_dot2c_f32_bf16 v7, v89, v53
  v_dot2c_f32_bf16 v7, v90, v54
  v_dot2c_f32_bf16 v7, v91, v55
  v_dot2c_f32_bf16 v8, v92, v44
  v_dot2c_f32_bf16 v8, v93, v45
  v_dot2c_f32_bf16 v8, v94, v46
  v_dot2c_f32_bf16 v8, v95, v47
  v_dot2c_f32_bf16 v8, v96, v48
  v_dot2c_f32_bf16 v8, v97, v49
  v_dot2c_f32_bf16 v8, v98, v50
  v_dot2c_f32_bf16 v8, v99, v51
  v_dot2c_f32_bf16 v8, v100, v52
  v_dot2c_f32_bf16 v8, v101, v53
  v_dot2c_f32_bf16 v8, v102, v54
  v_dot2c_f32_bf16 v8, v103, v55
  v_add_f32_dpp v9, v7, v7 row_half_mirror row_mask:0xf bank_mask:0x5
  s_nop 1
  v_add_f32_dpp v9, v8, v8 row_half_mirror row_mask:0xf bank_mask:0xa
  s_nop 1
  v_add_f32_dpp v9, v9, v9 quad_perm:[1,0,3,2] row_mask:0xf bank_mask:0xf
  s_nop 1
  v_add_f32_dpp v9, v9, v9 quad_perm:[2,3,0,1] row_mask:0xf bank_mask:0xf
  v_cvt_pk_bf16_f32 v9, v9, v9
  v_and_b32 v9, 0xffff0000, v9
  v_mul_f32 v9, 0x3d93cd3a, v9
  v_cvt_pk_bf16_f32 v9, v9, v9
  v_and_b32 v9, 0xffff0000, v9
  v_max_f32 v8, v5, v9
  ds_write_b16_d16_hi v38, v9
  v_sub_f32 v7, v5, v8
  v_sub_f32 v10, v9, v8
  v_mul_f32 v7, 0x3fb8aa3b, v7
  v_mul_f32 v10, 0x3fb8aa3b, v10
  v_exp_f32 v7, v7
  v_exp_f32 v10, v10
  v_mov_b32 v5, v8
  v_add_u32 v38, 128, v38
  v_fma_f32 v6, v6, v7, v10
  buffer_load_dwordx4 v[80:83], v1, s[28:31], s60 offen offset:0 nt
  buffer_load_dwordx4 v[84:87], v1, s[28:31], s60 offen offset:128 nt
  buffer_load_dwordx4 v[88:91], v1, s[28:31], s60 offen offset:256 nt
  buffer_load_dwordx4 v[92:95], v1, s[28:31], s60 offen offset:3072 nt
  buffer_load_dwordx4 v[96:99], v1, s[28:31], s60 offen offset:3200 nt
  buffer_load_dwordx4 v[100:103], v1, s[28:31], s60 offen offset:3328 nt
  s_add_u32 s78, s78, 4
  s_lshl_b32 s60, s78, 2
  s_add_u32 s60, s60, s88
  s_mul_i32 s60, s60, 6144
  v_mov_b32 v7, 0
  v_mov_b32 v8, 0
  v_dot2c_f32_bf16 v7, v104, v44
  v_dot2c_f32_bf16 v7, v105, v45
  v_dot2c_f32_bf16 v7, v106, v46
  v_dot2c_f32_bf16 v7, v107, v47
  v_dot2c_f32_bf16 v7, v108, v48
  v_dot2c_f32_bf16 v7, v109, v49
  v_dot2c_f32_bf16 v7, v110, v50
  v_dot2c_f32_bf16 v7, v111, v51
  v_dot2c_f32_bf16 v7, v112, v52
  v_dot2c_f32_bf16 v7, v113, v53
  v_dot2c_f32_bf16 v7, v114, v54
  v_dot2c_f32_bf16 v7, v115, v55
  v_dot2c_f32_bf16 v8, v116, v44
  v_dot2c_f32_bf16 v8, v117, v45
  v_dot2c_f32_bf16 v8, v118, v46
  v_dot2c_f32_bf16 v8, v119, v47
  v_dot2c_f32_bf16 v8, v120, v48
  v_dot2c_f32_bf16 v8, v121, v49
  v_dot2c_f32_bf16 v8, v122, v50
  v_dot2c_f32_bf16 v8, v123, v51
  v_dot2c_f32_bf16 v8, v124, v52
  v_dot2c_f32_bf16 v8, v125, v53
  v_dot2c_f32_bf16 v8, v126, v54
  v_dot2c_f32_bf16 v8, v127, v55
  v_add_f32_dpp v9, v7, v7 row_half_mirror row_mask:0xf bank_mask:0x5
  s_nop 1
  v_add_f32_dpp v9, v8, v8 row_half_mirror row_mask:0xf bank_mask:0xa
  s_nop 1
  v_add_f32_dpp v9, v9, v9 quad_perm:[1,0,3,2] row_mask:0xf bank_mask:0xf
  s_nop 1
  v_add_f32_dpp v9, v9, v9 quad_perm:[2,3,0,1] row_mask:0xf bank_mask:0xf
  v_cvt_pk_bf16_f32 v9, v9, v9
  v_and_b32 v9, 0xffff0000, v9
  v_mul_f32 v9, 0x3d93cd3a, v9
  v_cvt_pk_bf16_f32 v9, v9, v9
  v_and_b32 v9, 0xffff0000, v9
  v_max_f32 v8, v5, v9
  ds_write_b16_d16_hi v38, v9
  v_sub_f32 v7, v5, v8
  v_sub_f32 v10, v9, v8
  v_mul_f32 v7, 0x3fb8aa3b, v7
  v_mul_f32 v10, 0x3fb8aa3b, v10
  v_exp_f32 v7, v7
  v_exp_f32 v10, v10
  v_mov_b32 v5, v8
  v_add_u32 v38, 128, v38
  v_fma_f32 v6, v6, v7, v10
  v_mov_b32 v7, 0
  v_mov_b32 v8, 0
  v_dot2c_f32_bf16 v7, v128, v44
  v_dot2c_f32_bf16 v7, v129, v45
  v_dot2c_f32_bf16 v7, v130, v46
  v_dot2c_f32_bf16 v7, v131, v47
  v_dot2c_f32_bf16 v7, v132, v48
  v_dot2c_f32_bf16 v7, v133, v49
  v_dot2c_f32_bf16 v7, v134, v50
  v_dot2c_f32_bf16 v7, v135, v51
  v_dot2c_f32_bf16 v7, v136, v52
  v_dot2c_f32_bf16 v7, v137, v53
  v_dot2c_f32_bf16 v7, v138, v54
  v_dot2c_f32_bf16 v7, v139, v55
  v_dot2c_f32_bf16 v8, v140, v44
  v_dot2c_f32_bf16 v8, v141, v45
  v_dot2c_f32_bf16 v8, v142, v46
  v_dot2c_f32_bf16 v8, v143, v47
  v_dot2c_f32_bf16 v8, v144, v48
  v_dot2c_f32_bf16 v8, v145, v49
  v_dot2c_f32_bf16 v8, v146, v50
  v_dot2c_f32_bf16 v8, v147, v51
  v_dot2c_f32_bf16 v8, v148, v52
  v_dot2c_f32_bf16 v8, v149, v53
  v_dot2c_f32_bf16 v8, v150, v54
  v_dot2c_f32_bf16 v8, v151, v55
  v_add_f32_dpp v9, v7, v7 row_half_mirror row_mask:0xf bank_mask:0x5
  s_nop 1
  v_add_f32_dpp v9, v8, v8 row_half_mirror row_mask:0xf bank_mask:0xa
  s_nop 1
  v_add_f32_dpp v9, v9, v9 quad_perm:[1,0,3,2] row_mask:0xf bank_mask:0xf
  s_nop 1
  v_add_f32_dpp v9, v9, v9 quad_perm:[2,3,0,1] row_mask:0xf bank_mask:0xf
  v_cvt_pk_bf16_f32 v9, v9, v9
  v_and_b32 v9, 0xffff0000, v9
  v_mul_f32 v9, 0x3d93cd3a, v9
  v_cvt_pk_bf16_f32 v9, v9, v9
  v_and_b32 v9, 0xffff0000, v9
  v_max_f32 v8, v5, v9
  ds_write_b16_d16_hi v38, v9
  v_sub_f32 v7, v5, v8
  v_sub_f32 v10, v9, v8
  v_mul_f32 v7, 0x3fb8aa3b, v7
  v_mul_f32 v10, 0x3fb8aa3b, v10
  v_exp_f32 v7, v7
  v_exp_f32 v10, v10
  v_mov_b32 v5, v8
  v_add_u32 v38, 128, v38
  v_fma_f32 v6, v6, v7, v10
  v_mov_b32 v7, 0
  v_mov_b32 v8, 0
  v_dot2c_f32_bf16 v7, v152, v44
  v_dot2c_f32_bf16 v7, v153, v45
  v_dot2c_f32_bf16 v7, v154, v46
  v_dot2c_f32_bf16 v7, v155, v47
  v_dot2c_f32_bf16 v7, v156, v48
  v_dot2c_f32_bf16 v7, v157, v49
  v_dot2c_f32_bf16 v7, v158, v50
  v_dot2c_f32_bf16 v7, v159, v51
  v_dot2c_f32_bf16 v7, v160, v52
  v_dot2c_f32_bf16 v7, v161, v53
  v_dot2c_f32_bf16 v7, v162, v54
  v_dot2c_f32_bf16 v7, v163, v55
  v_dot2c_f32_bf16 v8, v164, v44
  v_dot2c_f32_bf16 v8, v165, v45
  v_dot2c_f32_bf16 v8, v166, v46
  v_dot2c_f32_bf16 v8, v167, v47
  v_dot2c_f32_bf16 v8, v168, v48
  v_dot2c_f32_bf16 v8, v169, v49
  v_dot2c_f32_bf16 v8, v170, v50
  v_dot2c_f32_bf16 v8, v171, v51
  v_dot2c_f32_bf16 v8, v172, v52
  v_dot2c_f32_bf16 v8, v173, v53
  v_dot2c_f32_bf16 v8, v174, v54
  v_dot2c_f32_bf16 v8, v175, v55
  v_add_f32_dpp v9, v7, v7 row_half_mirror row_mask:0xf bank_mask:0x5
  s_nop 1
  v_add_f32_dpp v9, v8, v8 row_half_mirror row_mask:0xf bank_mask:0xa
  s_nop 1
  v_add_f32_dpp v9, v9, v9 quad_perm:[1,0,3,2] row_mask:0xf bank_mask:0xf
  s_nop 1
  v_add_f32_dpp v9, v9, v9 quad_perm:[2,3,0,1] row_mask:0xf bank_mask:0xf
  v_cvt_pk_bf16_f32 v9, v9, v9
  v_and_b32 v9, 0xffff0000, v9
  v_mul_f32 v9, 0x3d93cd3a, v9
  v_cvt_pk_bf16_f32 v9, v9, v9
  v_and_b32 v9, 0xffff0000, v9
  v_max_f32 v8, v5, v9
  ds_write_b16_d16_hi v38, v9
  v_sub_f32 v7, v5, v8
  v_sub_f32 v10, v9, v8
  v_mul_f32 v7, 0x3fb8aa3b, v7
  v_mul_f32 v10, 0x3fb8aa3b, v10
  v_exp_f32 v7, v7
  v_exp_f32 v10, v10
  v_mov_b32 v5, v8
  v_add_u32 v38, 128, v38
  v_fma_f32 v6, v6, v7, v10
  v_mov_b32 v7, 0
  v_mov_b32 v8, 0
  v_dot2c_f32_bf16 v7, v176, v44
  v_dot2c_f32_bf16 v7, v177, v45
  v_dot2c_f32_bf16 v7, v178, v46
  v_dot2c_f32_bf16 v7, v179, v47
  v_dot2c_f32_bf16 v7, v180, v48
  v_dot2c_f32_bf16 v7, v181, v49
  v_dot2c_f32_bf16 v7, v182, v50
  v_dot2c_f32_bf16 v7, v183, v51
  v_dot2c_f32_bf16 v7, v184, v52
  v_dot2c_f32_bf16 v7, v185, v53
  v_dot2c_f32_bf16 v7, v186, v54
  v_dot2c_f32_bf16 v7, v187, v55
  v_dot2c_f32_bf16 v8, v188, v44
  v_dot2c_f32_bf16 v8, v189, v45
  v_dot2c_f32_bf16 v8, v190, v46
  v_dot2c_f32_bf16 v8, v191, v47
  v_dot2c_f32_bf16 v8, v192, v48
  v_dot2c_f32_bf16 v8, v193, v49
  v_dot2c_f32_bf16 v8, v194, v50
  v_dot2c_f32_bf16 v8, v195, v51
  v_dot2c_f32_bf16 v8, v196, v52
  v_dot2c_f32_bf16 v8, v197, v53
  v_dot2c_f32_bf16 v8, v198, v54
  v_dot2c_f32_bf16 v8, v199, v55
  v_add_f32_dpp v9, v7, v7 row_half_mirror row_mask:0xf bank_mask:0x5
  s_nop 1
  v_add_f32_dpp v9, v8, v8 row_half_mirror row_mask:0xf bank_mask:0xa
  s_nop 1
  v_add_f32_dpp v9, v9, v9 quad_perm:[1,0,3,2] row_mask:0xf bank_mask:0xf
  s_nop 1
  v_add_f32_dpp v9, v9, v9 quad_perm:[2,3,0,1] row_mask:0xf bank_mask:0xf
  v_cvt_pk_bf16_f32 v9, v9, v9
  v_and_b32 v9, 0xffff0000, v9
  v_mul_f32 v9, 0x3d93cd3a, v9
  v_cvt_pk_bf16_f32 v9, v9, v9
  v_and_b32 v9, 0xffff0000, v9
  v_max_f32 v8, v5, v9
  ds_write_b16_d16_hi v38, v9
  v_sub_f32 v7, v5, v8
  v_sub_f32 v10, v9, v8
  v_mul_f32 v7, 0x3fb8aa3b, v7
  v_mul_f32 v10, 0x3fb8aa3b, v10
  v_exp_f32 v7, v7
  v_exp_f32 v10, v10
  v_mov_b32 v5, v8
  v_add_u32 v38, 128, v38
  v_fma_f32 v6, v6, v7, v10
  s_cmp_ge_u32 s79, s93
  s_cbranch_scc0 L_ne_kx
  s_call_b64 s[26:27], H_K
L_ne_kx:
  s_add_u32 s79, s79, 4
  v_mov_b32 v7, 0
  v_mov_b32 v8, 0
  s_waitcnt vmcnt(11)
  v_dot2c_f32_bf16 v7, v200, v44
  v_dot2c_f32_bf16 v7, v201, v45
  v_dot2c_f32_bf16 v7, v202, v46
  v_dot2c_f32_bf16 v7, v203, v47
  s_waitcnt vmcnt(10)
  v_dot2c_f32_bf16 v7, v204, v48
  v_dot2c_f32_bf16 v7, v205, v49
  v_dot2c_f32_bf16 v7, v206, v50
  v_dot2c_f32_bf16 v7, v207, v51
  s_waitcnt vmcnt(9)
  v_dot2c_f32_bf16 v7, v208, v52
  v_dot2c_f32_bf16 v7, v209, v53
  v_dot2c_f32_bf16 v7, v210, v54
  v_dot2c_f32_bf16 v7, v211, v55
  s_waitcnt vmcnt(8)
  v_dot2c_f32_bf16 v8, v212, v44
  v_dot2c_f32_bf16 v8, v213, v45
  v_dot2c_f32_bf16 v8, v214, v46
  v_dot2c_f32_bf16 v8, v215, v47
  s_waitcnt vmcnt(7)
  v_dot2c_f32_bf16 v8, v216, v48
  v_dot2c_f32_bf16 v8, v217, v49
  v_dot2c_f32_bf16 v8, v218, v50
  v_dot2c_f32_bf16 v8, v219, v51
  s_waitcnt vmcnt(6)
  v_dot2c_f32_bf16 v8, v220, v52
  v_dot2c_f32_bf16 v8, v221, v53
  v_dot2c_f32_bf16 v8, v222, v54
  v_dot2c_f32_bf16 v8, v223, v55
  v_add_f32_dpp v9, v7, v7 row_half_mirror row_mask:0xf bank_mask:0x5
  s_nop 1
  v_add_f32_dpp v9, v8, v8 row_half_mirror row_mask:0xf bank_mask:0xa
  s_nop 1
  v_add_f32_dpp v9, v9, v9 quad_perm:[1,0,3,2] row_mask:0xf bank_mask:0xf
  s_nop 1
  v_add_f32_dpp v9, v9, v9 quad_perm:[2,3,0,1] row_mask:0xf bank_mask:0xf
  v_cvt_pk_bf16_f32 v9, v9, v9
  v_and_b32 v9, 0xffff0000, v9
  v_mul_f32 v9, 0x3d93cd3a, v9
  v_cvt_pk_bf16_f32 v9, v9, v9
  v_and_b32 v9, 0xffff0000, v9
  v_max_f32 v8, v5, v9
  ds_write_b16_d16_hi v38, v9
  v_sub_f32 v7, v5, v8
  v_sub_f32 v10, v9, v8
  v_mul_f32 v7, 0x3fb8aa3b, v7
  v_mul_f32 v10, 0x3fb8aa3b, v10
  v_exp_f32 v7, v7
  v_exp_f32 v10, v10
  v_mov_b32 v5, v8
  v_add_u32 v38, 128, v38
  v_fma_f32 v6, v6, v7, v10
  s_mov_b32 s61, 13
L_kloop:
  s_barrier
  s_cmp_ge_u32 s79, s93
  s_cbranch_scc0 L_ne_ka
  s_call_b64 s[26:27], H_K
L_ne_ka:
  v_mov_b32 v7, 0
  v_mov_b32 v8, 0
  s_waitcnt vmcnt(5)
  buffer_load_dwordx4 v[104:107], v1, s[28:31], s60 offen offset:0 nt
  v_dot2c_f32_bf16 v7, v80, v44
  v_dot2c_f32_bf16 v7, v81, v45
  v_dot2c_f32_bf16 v7, v82, v46
  v_dot2c_f32_bf16 v7, v83, v47
  s_waitcnt vmcnt(5)
  buffer_load_dwordx4 v[108:111], v1, s[28:31], s60 offen offset:128 nt
  v_dot2c_f32_bf16 v7, v84, v48
  v_dot2c_f32_bf16 v7, v85, v49
  v_dot2c_f32_bf16 v7, v86, v50
  v_dot2c_f32_bf16 v7, v87, v51
  s_waitcnt vmcnt(5)
  buffer_load_dwordx4 v[112:115], v1, s[28:31], s60 offen offset:256 nt
  v_dot2c_f32_bf16 v7, v88, v52
  v_dot2c_f32_bf16 v7, v89, v53
  v_dot2c_f32_bf16 v7, v90, v54
  v_dot2c_f32_bf16 v7, v91, v55
  s_waitcnt vmcnt(5)
  buffer_load_dwordx4 v[116:119], v1, s[28:31], s60 offen offset:3072 nt
  v_dot2c_f32_bf16 v8, v92, v44
  v_dot2c_f32_bf16 v8, v93, v45
  v_dot2c_f32_bf16 v8, v94, v46
  v_dot2c_f32_bf16 v8, v95, v47
  s_waitcnt vmcnt(5)
  buffer_load_dwordx4 v[120:123], v1, s[28:31], s60 offen offset:3200 nt
  v_dot2c_f32_bf16 v8, v96, v48
  v_dot2c_f32_bf16 v8, v97, v49
  v_dot2c_f32_bf16 v8, v98, v50
  v_dot2c_f32_bf16 v8, v99, v51
  s_waitcnt vmcnt(5)
  buffer_load_dwordx4 v[124:127], v1, s[28:31], s60 offen offset:3328 nt
  v_dot2c_f32_bf16 v8, v100, v52
  v_dot2c_f32_bf16 v8, v101, v53
  v_dot2c_f32_bf16 v8, v102, v54
  v_dot2c_f32_bf16 v8, v103, v55
  s_add_u32 s79, s79, 4
  s_add_u32 s78, s78, 4
  s_cmp_ge_u32 s78, 128
  s_cselect_b32 s28, s8, s28
  s_cselect_b32 s29, s9, s29
  s_and_b32 s78, s78, 127
  s_lshl_b32 s65, s78, 2
  s_lshr_b32 s66, s78, 2
  s_bitcmp1_b32 65280, s66
  s_cselect_b32 s66, s22, s88
  s_add_u32 s65, s65, s66
  s_add_u32 s66, s78, s90
  s_cmp_ge_u32 s78, 84
  s_cselect_b32 s65, s89, s65
  s_cmp_ge_u32 s78, s92
  s_cselect_b32 s65, s66, s65
  s_mul_i32 s60, s65, 6144
  v_add_f32_dpp v9, v7, v7 row_half_mirror row_mask:0xf bank_mask:0x5
  s_nop 1
  v_add_f32_dpp v9, v8, v8 row_half_mirror row_mask:0xf bank_mask:0xa
  s_nop 1
  v_add_f32_dpp v9, v9, v9 quad_perm:[1,0,3,2] row_mask:0xf bank_mask:0xf
  s_nop 1
  v_add_f32_dpp v9, v9, v9 quad_perm:[2,3,0,1] row_mask:0xf bank_mask:0xf
  v_cvt_pk_bf16_f32 v9, v9, v9
  v_and_b32 v9, 0xffff0000, v9
  v_mul_f32 v9, 0x3d93cd3a, v9
  v_cvt_pk_bf16_f32 v9, v9, v9
  v_and_b32 v9, 0xffff0000, v9
  v_max_f32 v8, v5, v9
  ds_write_b16_d16_hi v38, v9
  v_sub_f32 v7, v5, v8
  v_sub_f32 v10, v9, v8
  v_mul_f32 v7, 0x3fb8aa3b, v7
  v_mul_f32 v10, 0x3fb8aa3b, v10
  v_exp_f32 v7, v7
  v_exp_f32 v10, v10
  v_mov_b32 v5, v8
  v_add_u32 v38, 128, v38
  v_fma_f32 v6, v6, v7, v10
  s_cmp_ge_u32 s79, s93
  s_cbranch_scc0 L_ne_kb
  s_call_b64 s[26:27], H_K
L_ne_kb:
  v_mov_b32 v7, 0
  v_mov_b32 v8, 0
  s_waitcnt vmcnt(5)
  buffer_load_dwordx4 v[80:83], v1, s[28:31], s60 offen offset:0 nt
  v_dot2c_f32_bf16 v7, v104, v44
  v_dot2c_f32_bf16 v7, v105, v45
  v_dot2c_f32_bf16 v7, v106, v46
  v_dot2c_f32_bf16 v7, v107, v47
  s_waitcnt vmcnt(5)
  buffer_load_dwordx4 v[84:87], v1, s[28:31], s60 offen offset:128 nt
  v_dot2c_f32_bf16 v7, v108, v48
  v_dot2c_f32_bf16 v7, v109, v49
  v_dot2c_f32_bf16 v7, v110, v50
  v_dot2c_f32_bf16 v7, v111, v51
  s_waitcnt vmcnt(5)
  buffer_load_dwordx4 v[88:91], v1, s[28:31], s60 offen offset:256 nt
  v_dot2c_f32_bf16 v7, v112, v52
  v_dot2c_f32_bf16 v7, v113, v53
  v_dot2c_f32_bf16 v7, v114, v54
  v_dot2c_f32_bf16 v7, v115, v55
  s_waitcnt vmcnt(5)
  buffer_load_dwordx4 v[92:95], v1, s[28:31], s60 offen offset:3072 nt
  v_dot2c_f32_bf16 v8, v116, v44
  v_dot2c_f32_bf16 v8, v117, v45
  v_dot2c_f32_bf16 v8, v118, v46
  v_dot2c_f32_bf16 v8, v119, v47
  s_waitcnt vmcnt(5)
  buffer_load_dwordx4 v[96:99], v1, s[28:31], s60 offen offset:3200 nt
  v_dot2c_f32_bf16 v8, v120, v48
  v_dot2c_f32_bf16 v8, v121, v49
  v_dot2c_f32_bf16 v8, v122, v50
  v_dot2c_f32_bf16 v8, v123, v51
  s_waitcnt vmcnt(5)
  buffer_load_dwordx4 v[100:103], v1, s[28:31], s60 offen offset:3328 nt
  v_dot2c_f32_bf16 v8, v124, v52
  v_dot2c_f32_bf16 v8, v125, v53
  v_dot2c_f32_bf16 v8, v126, v54
  v_dot2c_f32_bf16 v8, v127, v55
  s_add_u32 s79, s79, 4
  s_add_u32 s78, s78, 4
  s_lshl_b32 s65, s78, 2
  s_lshr_b32 s66, s78, 2
  s_bitcmp1_b32 65280, s66
  s_cselect_b32 s66, s22, s88
  s_add_u32 s65, s65, s66
  s_add_u32 s66, s78, s90
  s_cmp_ge_u32 s78, 84
  s_cselect_b32 s65, s89, s65
  s_cmp_ge_u32 s78, s92
  s_cselect_b32 s65, s66, s65
  s_mul_i32 s60, s65, 6144
  v_add_f32_dpp v9, v7, v7 row_half_mirror row_mask:0xf bank_mask:0x5
  s_nop 1
  v_add_f32_dpp v9, v8, v8 row_half_mirror row_mask:0xf bank_mask:0xa
  s_nop 1
  v_add_f32_dpp v9, v9, v9 quad_perm:[1,0,3,2] row_mask:0xf bank_mask:0xf
  s_nop 1
  v_add_f32_dpp v9, v9, v9 quad_perm:[2,3,0,1] row_mask:0xf bank_mask:0xf
  v_cvt_pk_bf16_f32 v9, v9, v9
  v_and_b32 v9, 0xffff0000, v9
  v_mul_f32 v9, 0x3d93cd3a, v9
  v_cvt_pk_bf16_f32 v9, v9, v9
  v_and_b32 v9, 0xffff0000, v9
  v_max_f32 v8, v5, v9
  ds_write_b16_d16_hi v38, v9
  v_sub_f32 v7, v5, v8
  v_sub_f32 v10, v9, v8
  v_mul_f32 v7, 0x3fb8aa3b, v7
  v_mul_f32 v10, 0x3fb8aa3b, v10
  v_exp_f32 v7, v7
  v_exp_f32 v10, v10
  v_mov_b32 v5, v8
  v_add_u32 v38, 128, v38
  v_fma_f32 v6, v6, v7, v10
  s_sub_u32 s61, s61, 1
  s_cmp_lg_u32 s61, 0
  s_cbranch_scc1 L_kloop
  s_call_b64 s[26:27], H_KS
  s_mov_b32 s95, 0
  s_mov_b32 s94, -1
  s_mov_b32 s93, 8
  s_mov_b32 s79, s3
  s_barrier
  s_cmp_lg_u32 s3, 3
  s_cbranch_scc1 L_nosc
  v_min_u32 v9, 31, v4
  v_lshlrev_b32 v9, 4, v9
  ds_read_b128 v[20:23], v9 offset:61056
  s_mul_i32 s70, s21, 512
  s_add_u32 s70, s70, 589824
  v_lshrrev_b32 v10, 7, v9
  v_and_b32 v7, 127, v9
  v_mul_u32_u24 v10, 128, v10
  v_add_u32 v10, v10, v7
  s_waitcnt lgkmcnt(0)
  buffer_store_dwordx4 v[20:23], v10, s[48:51], s70 offen sc1
L_nosc:
  s_call_b64 s[26:27], H_VS
  s_mov_b32 s61, 13
L_vloop:
  s_barrier
  ds_read_b32 v36, v39
  v_add_u32 v39, 128, v39
  s_cmp_ge_u32 s79, s93
  s_cbranch_scc0 L_ne_va
  s_call_b64 s[26:27], H_V
L_ne_va:
  s_waitcnt vmcnt(5)
  buffer_load_dwordx4 v[104:107], v1, s[28:31], s60 offen offset:0 nt
  s_waitcnt lgkmcnt(0)
  v_lshlrev_b32 v7, 16, v36
  v_and_b32 v8, 0xffff0000, v36
  v_sub_f32 v7, v7, v5
  v_sub_f32 v8, v8, v5
  v_mul_f32 v7, 0x3fb8aa3b, v7
  v_mul_f32 v8, 0x3fb8aa3b, v8
  v_exp_f32 v7, v7
  v_exp_f32 v8, v8
  v_mul_f32 v7, v7, v6
  v_mul_f32 v8, v8, v6
  v_cvt_pk_bf16_f32 v9, v7, v8
  v_and_b32 v11, 0xffff, v9
  v_lshlrev_b32 v12, 16, v9
  v_lshrrev_b32 v13, 16, v9
  v_and_b32 v14, 0xffff0000, v9
  v_dot2c_f32_bf16 v56, v80, v11
  v_dot2c_f32_bf16 v57, v80, v12
  v_dot2c_f32_bf16 v58, v81, v11
  v_dot2c_f32_bf16 v59, v81, v12
  v_dot2c_f32_bf16 v60, v82, v11
  v_dot2c_f32_bf16 v61, v82, v12
  v_dot2c_f32_bf16 v62, v83, v11
  v_dot2c_f32_bf16 v63, v83, v12
  s_waitcnt vmcnt(5)
  buffer_load_dwordx4 v[108:111], v1, s[28:31], s60 offen offset:128 nt
  v_dot2c_f32_bf16 v64, v84, v11
  v_dot2c_f32_bf16 v65, v84, v12
  v_dot2c_f32_bf16 v66, v85, v11
  v_dot2c_f32_bf16 v67, v85, v12
  v_dot2c_f32_bf16 v68, v86, v11
  v_dot2c_f32_bf16 v69, v86, v12
  v_dot2c_f32_bf16 v70, v87, v11
  v_dot2c_f32_bf16 v71, v87, v12
  s_waitcnt vmcnt(5)
  buffer_load_dwordx4 v[112:115], v1, s[28:31], s60 offen offset:256 nt
  v_dot2c_f32_bf16 v72, v88, v11
  v_dot2c_f32_bf16 v73, v88, v12
  v_dot2c_f32_bf16 v74, v89, v11
  v_dot2c_f32_bf16 v75, v89, v12
  v_dot2c_f32_bf16 v76, v90, v11
  v_dot2c_f32_bf16 v77, v90, v12
  v_dot2c_f32_bf16 v78, v91, v11
  v_dot2c_f32_bf16 v79, v91, v12
  s_waitcnt vmcnt(5)
  buffer_load_dwordx4 v[116:119], v1, s[28:31], s60 offen offset:3072 nt
  v_dot2c_f32_bf16 v56, v92, v13
  v_dot2c_f32_bf16 v57, v92, v14
  v_dot2c_f32_bf16 v58, v93, v13
  v_dot2c_f32_bf16 v59, v93, v14
  v_dot2c_f32_bf16 v60, v94, v13
  v_dot2c_f32_bf16 v61, v94, v14
  v_dot2c_f32_bf16 v62, v95, v13
  v_dot2c_f32_bf16 v63, v95, v14
  s_waitcnt vmcnt(5)
  buffer_load_dwordx4 v[120:123], v1, s[28:31], s60 offen offset:3200 nt
  v_dot2c_f32_bf16 v64, v96, v13
  v_dot2c_f32_bf16 v65, v96, v14
  v_dot2c_f32_bf16 v66, v97, v13
  v_dot2c_f32_bf16 v67, v97, v14
  v_dot2c_f32_bf16 v68, v98, v13
  v_dot2c_f32_bf16 v69, v98, v14
  v_dot2c_f32_bf16 v70, v99, v13
  v_dot2c_f32_bf16 v71, v99, v14
  s_waitcnt vmcnt(5)
  buffer_load_dwordx4 v[124:127], v1, s[28:31], s60 offen offset:3328 nt
  v_dot2c_f32_bf16 v72, v100, v13
  v_dot2c_f32_bf16 v73, v100, v14
  v_dot2c_f32_bf16 v74, v101, v13
  v_dot2c_f32_bf16 v75, v101, v14
  v_dot2c_f32_bf16 v76, v102, v13
  v_dot2c_f32_bf16 v77, v102, v14
  v_dot2c_f32_bf16 v78, v103, v13
  v_dot2c_f32_bf16 v79, v103, v14
  s_add_u32 s79, s79, 4
  s_add_u32 s78, s78, 4
  s_lshl_b32 s65, s78, 2
  s_lshr_b32 s66, s78, 2
  s_bitcmp1_b32 65280, s66
  s_cselect_b32 s66, s22, s88
  s_add_u32 s65, s65, s66
  s_add_u32 s66, s78, s90
  s_cmp_ge_u32 s78, 84
  s_cselect_b32 s65, s89, s65
  s_cmp_ge_u32 s78, s92
  s_cselect_b32 s65, s66, s65
  s_mul_i32 s60, s65, 6144
  ds_read_b32 v36, v39
  v_add_u32 v39, 128, v39
  s_cmp_ge_u32 s79, s93
  s_cbranch_scc0 L_ne_vb
  s_call_b64 s[26:27], H_V
L_ne_vb:
  s_waitcnt vmcnt(5)
  buffer_load_dwordx4 v[80:83], v1, s[28:31], s60 offen offset:0 nt
  s_waitcnt lgkmcnt(0)
  v_lshlrev_b32 v7, 16, v36
  v_and_b32 v8, 0xffff0000, v36
  v_sub_f32 v7, v7, v5
  v_sub_f32 v8, v8, v5
  v_mul_f32 v7, 0x3fb8aa3b, v7
  v_mul_f32 v8, 0x3fb8aa3b, v8
  v_exp_f32 v7, v7
  v_exp_f32 v8, v8
  v_mul_f32 v7, v7, v6
  v_mul_f32 v8, v8, v6
  v_cvt_pk_bf16_f32 v9, v7, v8
  v_and_b32 v11, 0xffff, v9
  v_lshlrev_b32 v12, 16, v9
  v_lshrrev_b32 v13, 16, v9
  v_and_b32 v14, 0xffff0000, v9
  v_dot2c_f32_bf16 v56, v104, v11
  v_dot2c_f32_bf16 v57, v104, v12
  v_dot2c_f32_bf16 v58, v105, v11
  v_dot2c_f32_bf16 v59, v105, v12
  v_dot2c_f32_bf16 v60, v106, v11
  v_dot2c_f32_bf16 v61, v106, v12
  v_dot2c_f32_bf16 v62, v107, v11
  v_dot2c_f32_bf16 v63, v107, v12
  s_waitcnt vmcnt(5)
  buffer_load_dwordx4 v[84:87], v1, s[28:31], s60 offen offset:128 nt
  v_dot2c_f32_bf16 v64, v108, v11
  v_dot2c_f32_bf16 v65, v108, v12
  v_dot2c_f32_bf16 v66, v109, v11
  v_dot2c_f32_bf16 v67, v109, v12
  v_dot2c_f32_bf16 v68, v110, v11
  v_dot2c_f32_bf16 v69, v110, v12
  v_dot2c_f32_bf16 v70, v111, v11
  v_dot2c_f32_bf16 v71, v111, v12
  s_waitcnt vmcnt(5)
  buffer_load_dwordx4 v[88:91], v1, s[28:31], s60 offen offset:256 nt
  v_dot2c_f32_bf16 v72, v112, v11
  v_dot2c_f32_bf16 v73, v112, v12
  v_dot2c_f32_bf16 v74, v113, v11
  v_dot2c_f32_bf16 v75, v113, v12
  v_dot2c_f32_bf16 v76, v114, v11
  v_dot2c_f32_bf16 v77, v114, v12
  v_dot2c_f32_bf16 v78, v115, v11
  v_dot2c_f32_bf16 v79, v115, v12
  s_waitcnt vmcnt(5)
  buffer_load_dwordx4 v[92:95], v1, s[28:31], s60 offen offset:3072 nt
  v_dot2c_f32_bf16 v56, v116, v13
  v_dot2c_f32_bf16 v57, v116, v14
  v_dot2c_f32_bf16 v58, v117, v13
  v_dot2c_f32_bf16 v59, v117, v14
  v_dot2c_f32_bf16 v60, v118, v13
  v_dot2c_f32_bf16 v61, v118, v14
  v_dot2c_f32_bf16 v62, v119, v13
  v_dot2c_f32_bf16 v63, v119, v14
  s_waitcnt vmcnt(5)
  buffer_load_dwordx4 v[96:99], v1, s[28:31], s60 offen offset:3200 nt
  v_dot2c_f32_bf16 v64, v120, v13
  v_dot2c_f32_bf16 v65, v120, v14
  v_dot2c_f32_bf16 v66, v121, v13
  v_dot2c_f32_bf16 v67, v121, v14
  v_dot2c_f32_bf16 v68, v122, v13
  v_dot2c_f32_bf16 v69, v122, v14
  v_dot2c_f32_bf16 v70, v123, v13
  v_dot2c_f32_bf16 v71, v123, v14
  s_waitcnt vmcnt(5)
  buffer_load_dwordx4 v[100:103], v1, s[28:31], s60 offen offset:3328 nt
  v_dot2c_f32_bf16 v72, v124, v13
  v_dot2c_f32_bf16 v73, v124, v14
  v_dot2c_f32_bf16 v74, v125, v13
  v_dot2c_f32_bf16 v75, v125, v14
  v_dot2c_f32_bf16 v76, v126, v13
  v_dot2c_f32_bf16 v77, v126, v14
  v_dot2c_f32_bf16 v78, v127, v13
  v_dot2c_f32_bf16 v79, v127, v14
  s_add_u32 s79, s79, 4
  s_add_u32 s78, s78, 4
  s_lshl_b32 s65, s78, 2
  s_lshr_b32 s66, s78, 2
  s_bitcmp1_b32 65280, s66
  s_cselect_b32 s66, s22, s88
  s_add_u32 s65, s65, s66
  s_add_u32 s66, s78, s90
  s_cmp_ge_u32 s78, 84
  s_cselect_b32 s65, s89, s65
  s_cmp_ge_u32 s78, s92
  s_cselect_b32 s65, s66, s65
  s_mul_i32 s60, s65, 6144
  s_sub_u32 s61, s61, 1
  s_cmp_lg_u32 s61, 0
  s_cbranch_scc1 L_vloop
  ds_read_b32 v36, v39
  v_add_u32 v39, 128, v39
  s_cmp_ge_u32 s79, s93
  s_cbranch_scc0 L_ne_vc
  s_call_b64 s[26:27], H_V
L_ne_vc:
  ds_read_b32 v37, v39
  v_add_u32 v39, 128, v39
  v_min_u32 v9, 47, v4
  v_lshlrev_b32 v16, 4, v9
  s_mul_i32 s66, s3, 3072
  s_add_u32 s66, s66, 61568
  v_add_u32 v18, s66, v16
  s_mul_i32 s67, s3, 10
  s_lshr_b32 s67, s20, s67
  s_bfe_u32 s68, s67, 0x70003
  s_and_b32 s67, s67, 7
  s_mul_i32 s67, s67, 98304
  s_add_u32 s75, s67, 786432
  s_and_b32 s65, s68, 0x43
  s_bfe_u32 s66, s68, 0x30003
  s_lshl_b32 s66, s66, 2
  s_or_b32 s65, s65, s66
  s_bfe_u32 s66, s68, 0x10002
  s_xor_b32 s66, s66, s14
  s_lshl_b32 s66, s66, 5
  s_or_b32 s65, s65, s66
  v_lshrrev_b32 v9, 8, v16
  v_mov_b32 v231, s65
  v_lshl_add_u32 v231, v9, 7, v231
  v_and_b32 v9, 255, v16
  v_lshl_add_u32 v231, v231, 8, v9
  s_mov_b32 s77, 1048576
  s_waitcnt vmcnt(5)
  buffer_load_dwordx4 v[104:107], v1, s[28:31], s60 offen offset:0 nt
  s_waitcnt lgkmcnt(0)
  v_lshlrev_b32 v7, 16, v36
  v_and_b32 v8, 0xffff0000, v36
  v_sub_f32 v7, v7, v5
  v_sub_f32 v8, v8, v5
  v_mul_f32 v7, 0x3fb8aa3b, v7
  v_mul_f32 v8, 0x3fb8aa3b, v8
  v_exp_f32 v7, v7
  v_exp_f32 v8, v8
  v_mul_f32 v7, v7, v6
  v_mul_f32 v8, v8, v6
  v_cvt_pk_bf16_f32 v9, v7, v8
  v_and_b32 v11, 0xffff, v9
  v_lshlrev_b32 v12, 16, v9
  v_lshrrev_b32 v13, 16, v9
  v_and_b32 v14, 0xffff0000, v9
  v_dot2c_f32_bf16 v56, v80, v11
  v_dot2c_f32_bf16 v57, v80, v12
  v_dot2c_f32_bf16 v58, v81, v11
  v_dot2c_f32_bf16 v59, v81, v12
  v_dot2c_f32_bf16 v60, v82, v11
  v_dot2c_f32_bf16 v61, v82, v12
  v_dot2c_f32_bf16 v62, v83, v11
  v_dot2c_f32_bf16 v63, v83, v12
  s_cmp_lg_u32 s3, 0
  s_cbranch_scc1 L_p0s
  s_mov_b32 s34, 1
  s_atomic_add s34, s[32:33], 0 glc
L_p0s:
  s_waitcnt vmcnt(5)
  buffer_load_dwordx4 v[108:111], v1, s[28:31], s60 offen offset:128 nt
  v_dot2c_f32_bf16 v64, v84, v11
  v_dot2c_f32_bf16 v65, v84, v12
  v_dot2c_f32_bf16 v66, v85, v11
  v_dot2c_f32_bf16 v67, v85, v12
  v_dot2c_f32_bf16 v68, v86, v11
  v_dot2c_f32_bf16 v69, v86, v12
  v_dot2c_f32_bf16 v70, v87, v11
  v_dot2c_f32_bf16 v71, v87, v12
  s_waitcnt vmcnt(5)
  buffer_load_dwordx4 v[112:115], v1, s[28:31], s60 offen offset:256 nt
  v_dot2c_f32_bf16 v72, v88, v11
  v_dot2c_f32_bf16 v73, v88, v12
  v_dot2c_f32_bf16 v74, v89, v11
  v_dot2c_f32_bf16 v75, v89, v12
  v_dot2c_f32_bf16 v76, v90, v11
  v_dot2c_f32_bf16 v77, v90, v12
  v_dot2c_f32_bf16 v78, v91, v11
  v_dot2c_f32_bf16 v79, v91, v12
  s_waitcnt vmcnt(5)
  buffer_load_dwordx4 v[116:119], v1, s[28:31], s60 offen offset:3072 nt
  v_dot2c_f32_bf16 v56, v92, v13
  v_dot2c_f32_bf16 v57, v92, v14
  v_dot2c_f32_bf16 v58, v93, v13
  v_dot2c_f32_bf16 v59, v93, v14
  v_dot2c_f32_bf16 v60, v94, v13
  v_dot2c_f32_bf16 v61, v94, v14
  v_dot2c_f32_bf16 v62, v95, v13
  v_dot2c_f32_bf16 v63, v95, v14
  s_cmp_lg_u32 s3, 0
  s_cbranch_scc1 L_p1s
  s_waitcnt lgkmcnt(0)
  v_mov_b32 v229, s34
  ds_write_b32 v230, v229 offset:0
  s_waitcnt lgkmcnt(0)
  s_cmp_lt_u32 s34, s15
  s_cbranch_scc1 L_p1s
  s_mov_b32 s16, 1
  s_atomic_add s16, s[10:11], 0 glc
L_p1s:
  s_barrier
  ds_read_b32 v229, v230 offset:0
  s_waitcnt vmcnt(5)
  buffer_load_dwordx4 v[120:123], v1, s[28:31], s60 offen offset:3200 nt
  v_dot2c_f32_bf16 v64, v96, v13
  v_dot2c_f32_bf16 v65, v96, v14
  v_dot2c_f32_bf16 v66, v97, v13
  v_dot2c_f32_bf16 v67, v97, v14
  v_dot2c_f32_bf16 v68, v98, v13
  v_dot2c_f32_bf16 v69, v98, v14
  v_dot2c_f32_bf16 v70, v99, v13
  v_dot2c_f32_bf16 v71, v99, v14
  s_waitcnt vmcnt(5)
  buffer_load_dwordx4 v[124:127], v1, s[28:31], s60 offen offset:3328 nt
  v_dot2c_f32_bf16 v72, v100, v13
  v_dot2c_f32_bf16 v73, v100, v14
  v_dot2c_f32_bf16 v74, v101, v13
  v_dot2c_f32_bf16 v75, v101, v14
  v_dot2c_f32_bf16 v76, v102, v13
  v_dot2c_f32_bf16 v77, v102, v14
  v_dot2c_f32_bf16 v78, v103, v13
  v_dot2c_f32_bf16 v79, v103, v14
L_da:
  s_waitcnt lgkmcnt(0)
  v_readfirstlane_b32 s67, v229
  s_nop 1
  s_cmp_ge_u32 s67, s15
  s_cbranch_scc1 L_taila
  s_add_u32 s68, s67, 24
  s_mul_i32 s65, s67, s100
  s_lshr_b32 s65, s65, 16
  s_mul_i32 s66, s65, s35
  s_sub_u32 s66, s67, s66
  s_lshl_b32 s65, s65, 2
  s_add_u32 s65, s65, s3
  s_add_u32 s66, s66, s101
  s_lshr_b32 s69, s65, 2
  s_mul_i32 s69, s69, 128
  s_mul_i32 s67, s66, 512
  s_add_u32 s67, s67, s69
  s_and_b32 s69, s65, 3
  s_lshl_b32 s69, s69, 5
  s_add_u32 s67, s67, s69
  s_add_u32 s67, s67, 589824
  buffer_load_dword v36, v43, s[48:51], s67 offen sc1
  s_lshl_b32 s66, s66, 7
  s_add_u32 s66, s66, 65665
  s_mul_hi_u32 s66, s66, 0xaaaaaaab
  s_lshr_b32 s66, s66, 1
  s_add_u32 s66, s66, s65
  s_sub_u32 s66, s66, 16
  s_mul_i32 s60, s66, 6144
  s_cmp_ge_u32 s68, s15
  s_cbranch_scc1 L_bursta
  s_waitcnt vmcnt(6)
  buffer_load_dwordx4 v[80:83], v1, s[28:31], s60 offen offset:0 nt
  v_lshlrev_b32 v7, 16, v37
  v_and_b32 v8, 0xffff0000, v37
  v_sub_f32 v7, v7, v5
  v_sub_f32 v8, v8, v5
  v_mul_f32 v7, 0x3fb8aa3b, v7
  v_mul_f32 v8, 0x3fb8aa3b, v8
  v_exp_f32 v7, v7
  v_exp_f32 v8, v8
  v_mul_f32 v7, v7, v6
  v_mul_f32 v8, v8, v6
  v_cvt_pk_bf16_f32 v9, v7, v8
  v_and_b32 v11, 0xffff, v9
  v_lshlrev_b32 v12, 16, v9
  v_lshrrev_b32 v13, 16, v9
  v_and_b32 v14, 0xffff0000, v9
  v_dot2c_f32_bf16 v56, v104, v11
  v_dot2c_f32_bf16 v57, v104, v12
  v_dot2c_f32_bf16 v58, v105, v11
  v_dot2c_f32_bf16 v59, v105, v12
  v_dot2c_f32_bf16 v60, v106, v11
  v_dot2c_f32_bf16 v61, v106, v12
  v_dot2c_f32_bf16 v62, v107, v11
  v_dot2c_f32_bf16 v63, v107, v12
  s_cmp_lg_u32 s3, 0
  s_cbranch_scc1 L_p0a
  s_mov_b32 s34, 1
  s_atomic_add s34, s[32:33], 0 glc
L_p0a:
  s_waitcnt vmcnt(6)
  buffer_load_dwordx4 v[84:87], v1, s[28:31], s60 offen offset:128 nt
  v_dot2c_f32_bf16 v64, v108, v11
  v_dot2c_f32_bf16 v65, v108, v12
  v_dot2c_f32_bf16 v66, v109, v11
  v_dot2c_f32_bf16 v67, v109, v12
  v_dot2c_f32_bf16 v68, v110, v11
  v_dot2c_f32_bf16 v69, v110, v12
  v_dot2c_f32_bf16 v70, v111, v11
  v_dot2c_f32_bf16 v71, v111, v12
  s_waitcnt vmcnt(6)
  buffer_load_dwordx4 v[88:91], v1, s[28:31], s60 offen offset:256 nt
  v_dot2c_f32_bf16 v72, v112, v11
  v_dot2c_f32_bf16 v73, v112, v12
  v_dot2c_f32_bf16 v74, v113, v11
  v_dot2c_f32_bf16 v75, v113, v12
  v_dot2c_f32_bf16 v76, v114, v11
  v_dot2c_f32_bf16 v77, v114, v12
  v_dot2c_f32_bf16 v78, v115, v11
  v_dot2c_f32_bf16 v79, v115, v12
  s_waitcnt vmcnt(6)
  buffer_load_dwordx4 v[92:95], v1, s[28:31], s60 offen offset:3072 nt
  v_dot2c_f32_bf16 v56, v116, v13
  v_dot2c_f32_bf16 v57, v116, v14
  v_dot2c_f32_bf16 v58, v117, v13
  v_dot2c_f32_bf16 v59, v117, v14
  v_dot2c_f32_bf16 v60, v118, v13
  v_dot2c_f32_bf16 v61, v118, v14
  v_dot2c_f32_bf16 v62, v119, v13
  v_dot2c_f32_bf16 v63, v119, v14
  s_cmp_lg_u32 s3, 0
  s_cbranch_scc1 L_p1a
  s_waitcnt lgkmcnt(0)
  v_mov_b32 v229, s34
  ds_write_b32 v230, v229 offset:4
  s_waitcnt lgkmcnt(0)
  s_cmp_lt_u32 s34, s15
  s_cbranch_scc1 L_p1a
  s_mov_b32 s16, 1
  s_atomic_add s16, s[10:11], 0 glc
L_p1a:
  s_barrier
  ds_read_b32 v229, v230 offset:4
  s_waitcnt vmcnt(6)
  buffer_load_dwordx4 v[96:99], v1, s[28:31], s60 offen offset:3200 nt
  v_dot2c_f32_bf16 v64, v120, v13
  v_dot2c_f32_bf16 v65, v120, v14
  v_dot2c_f32_bf16 v66, v121, v13
  v_dot2c_f32_bf16 v67, v121, v14
  v_dot2c_f32_bf16 v68, v122, v13
  v_dot2c_f32_bf16 v69, v122, v14
  v_dot2c_f32_bf16 v70, v123, v13
  v_dot2c_f32_bf16 v71, v123, v14
  s_waitcnt vmcnt(6)
  buffer_load_dwordx4 v[100:103], v1, s[28:31], s60 offen offset:3328 nt
  v_dot2c_f32_bf16 v72, v124, v13
  v_dot2c_f32_bf16 v73, v124, v14
  v_dot2c_f32_bf16 v74, v125, v13
  v_dot2c_f32_bf16 v75, v125, v14
  v_dot2c_f32_bf16 v76, v126, v13
  v_dot2c_f32_bf16 v77, v126, v14
  v_dot2c_f32_bf16 v78, v127, v13
  v_dot2c_f32_bf16 v79, v127, v14
L_db:
  s_waitcnt lgkmcnt(0)
  v_readfirstlane_b32 s67, v229
  s_nop 1
  s_cmp_ge_u32 s67, s15
  s_cbranch_scc1 L_tailb
  s_add_u32 s68, s67, 24
  s_mul_i32 s65, s67, s100
  s_lshr_b32 s65, s65, 16
  s_mul_i32 s66, s65, s35
  s_sub_u32 s66, s67, s66
  s_lshl_b32 s65, s65, 2
  s_add_u32 s65, s65, s3
  s_add_u32 s66, s66, s101
  s_lshr_b32 s69, s65, 2
  s_mul_i32 s69, s69, 128
  s_mul_i32 s67, s66, 512
  s_add_u32 s67, s67, s69
  s_and_b32 s69, s65, 3
  s_lshl_b32 s69, s69, 5
  s_add_u32 s67, s67, s69
  s_add_u32 s67, s67, 589824
  buffer_load_dword v37, v43, s[48:51], s67 offen sc1
  s_lshl_b32 s66, s66, 7
  s_add_u32 s66, s66, 65665
  s_mul_hi_u32 s66, s66, 0xaaaaaaab
  s_lshr_b32 s66, s66, 1
  s_add_u32 s66, s66, s65
  s_sub_u32 s66, s66, 16
  s_mul_i32 s60, s66, 6144
  s_cmp_ge_u32 s68, s15
  s_cbranch_scc1 L_burstb
  s_waitcnt vmcnt(6)
  buffer_load_dwordx4 v[104:107], v1, s[28:31], s60 offen offset:0 nt
  v_lshlrev_b32 v7, 16, v36
  v_and_b32 v8, 0xffff0000, v36
  v_sub_f32 v7, v7, v5
  v_sub_f32 v8, v8, v5
  v_mul_f32 v7, 0x3fb8aa3b, v7
  v_mul_f32 v8, 0x3fb8aa3b, v8
  v_exp_f32 v7, v7
  v_exp_f32 v8, v8
  v_mul_f32 v7, v7, v6
  v_mul_f32 v8, v8, v6
  v_cvt_pk_bf16_f32 v9, v7, v8
  v_and_b32 v11, 0xffff, v9
  v_lshlrev_b32 v12, 16, v9
  v_lshrrev_b32 v13, 16, v9
  v_and_b32 v14, 0xffff0000, v9
  v_dot2c_f32_bf16 v56, v80, v11
  v_dot2c_f32_bf16 v57, v80, v12
  v_dot2c_f32_bf16 v58, v81, v11
  v_dot2c_f32_bf16 v59, v81, v12
  v_dot2c_f32_bf16 v60, v82, v11
  v_dot2c_f32_bf16 v61, v82, v12
  v_dot2c_f32_bf16 v62, v83, v11
  v_dot2c_f32_bf16 v63, v83, v12
  s_cmp_lg_u32 s3, 0
  s_cbranch_scc1 L_p0b
  s_mov_b32 s34, 1
  s_atomic_add s34, s[32:33], 0 glc
L_p0b:
  s_waitcnt vmcnt(6)
  buffer_load_dwordx4 v[108:111], v1, s[28:31], s60 offen offset:128 nt
  v_dot2c_f32_bf16 v64, v84, v11
  v_dot2c_f32_bf16 v65, v84, v12
  v_dot2c_f32_bf16 v66, v85, v11
  v_dot2c_f32_bf16 v67, v85, v12
  v_dot2c_f32_bf16 v68, v86, v11
  v_dot2c_f32_bf16 v69, v86, v12
  v_dot2c_f32_bf16 v70, v87, v11
  v_dot2c_f32_bf16 v71, v87, v12
  s_waitcnt vmcnt(6)
  buffer_load_dwordx4 v[112:115], v1, s[28:31], s60 offen offset:256 nt
  v_dot2c_f32_bf16 v72, v88, v11
  v_dot2c_f32_bf16 v73, v88, v12
  v_dot2c_f32_bf16 v74, v89, v11
  v_dot2c_f32_bf16 v75, v89, v12
  v_dot2c_f32_bf16 v76, v90, v11
  v_dot2c_f32_bf16 v77, v90, v12
  v_dot2c_f32_bf16 v78, v91, v11
  v_dot2c_f32_bf16 v79, v91, v12
  s_waitcnt vmcnt(6)
  buffer_load_dwordx4 v[116:119], v1, s[28:31], s60 offen offset:3072 nt
  v_dot2c_f32_bf16 v56, v92, v13
  v_dot2c_f32_bf16 v57, v92, v14
  v_dot2c_f32_bf16 v58, v93, v13
  v_dot2c_f32_bf16 v59, v93, v14
  v_dot2c_f32_bf16 v60, v94, v13
  v_dot2c_f32_bf16 v61, v94, v14
  v_dot2c_f32_bf16 v62, v95, v13
  v_dot2c_f32_bf16 v63, v95, v14
  s_cmp_lg_u32 s3, 0
  s_cbranch_scc1 L_p1b
  s_waitcnt lgkmcnt(0)
  v_mov_b32 v229, s34
  ds_write_b32 v230, v229 offset:0
  s_waitcnt lgkmcnt(0)
  s_cmp_lt_u32 s34, s15
  s_cbranch_scc1 L_p1b
  s_mov_b32 s16, 1
  s_atomic_add s16, s[10:11], 0 glc
L_p1b:
  s_barrier
  ds_read_b32 v229, v230 offset:0
  s_waitcnt vmcnt(6)
  buffer_load_dwordx4 v[120:123], v1, s[28:31], s60 offen offset:3200 nt
  v_dot2c_f32_bf16 v64, v96, v13
  v_dot2c_f32_bf16 v65, v96, v14
  v_dot2c_f32_bf16 v66, v97, v13
  v_dot2c_f32_bf16 v67, v97, v14
  v_dot2c_f32_bf16 v68, v98, v13
  v_dot2c_f32_bf16 v69, v98, v14
  v_dot2c_f32_bf16 v70, v99, v13
  v_dot2c_f32_bf16 v71, v99, v14
  s_waitcnt vmcnt(6)
  buffer_load_dwordx4 v[124:127], v1, s[28:31], s60 offen offset:3328 nt
  v_dot2c_f32_bf16 v72, v100, v13
  v_dot2c_f32_bf16 v73, v100, v14
  v_dot2c_f32_bf16 v74, v101, v13
  v_dot2c_f32_bf16 v75, v101, v14
  v_dot2c_f32_bf16 v76, v102, v13
  v_dot2c_f32_bf16 v77, v102, v14
  v_dot2c_f32_bf16 v78, v103, v13
  v_dot2c_f32_bf16 v79, v103, v14
  s_branch L_da
L_bursta:
  buffer_load_dwordx4 v[80:83], v1, s[28:31], s60 offen offset:0 nt
  s_waitcnt vmcnt(7)
  buffer_load_dwordx4 v[84:87], v1, s[28:31], s60 offen offset:128 nt
  v_lshlrev_b32 v7, 16, v37
  v_and_b32 v8, 0xffff0000, v37
  v_sub_f32 v7, v7, v5
  v_sub_f32 v8, v8, v5
  v_mul_f32 v7, 0x3fb8aa3b, v7
  v_mul_f32 v8, 0x3fb8aa3b, v8
  v_exp_f32 v7, v7
  v_exp_f32 v8, v8
  v_mul_f32 v7, v7, v6
  v_mul_f32 v8, v8, v6
  v_cvt_pk_bf16_f32 v9, v7, v8
  v_and_b32 v11, 0xffff, v9
  v_lshlrev_b32 v12, 16, v9
  v_lshrrev_b32 v13, 16, v9
  v_and_b32 v14, 0xffff0000, v9
  v_dot2c_f32_bf16 v56, v104, v11
  v_dot2c_f32_bf16 v57, v104, v12
  v_dot2c_f32_bf16 v58, v105, v11
  v_dot2c_f32_bf16 v59, v105, v12
  v_dot2c_f32_bf16 v60, v106, v11
  v_dot2c_f32_bf16 v61, v106, v12
  v_dot2c_f32_bf16 v62, v107, v11
  v_dot2c_f32_bf16 v63, v107, v12
  s_cmp_lg_u32 s3, 0
  s_cbranch_scc1 L_p0ua
  s_mov_b32 s34, 1
  s_atomic_add s34, s[32:33], 0 glc
L_p0ua:
  s_waitcnt vmcnt(7)
  buffer_load_dwordx4 v[88:91], v1, s[28:31], s60 offen offset:256 nt
  v_dot2c_f32_bf16 v64, v108, v11
  v_dot2c_f32_bf16 v65, v108, v12
  v_dot2c_f32_bf16 v66, v109, v11
  v_dot2c_f32_bf16 v67, v109, v12
  v_dot2c_f32_bf16 v68, v110, v11
  v_dot2c_f32_bf16 v69, v110, v12
  v_dot2c_f32_bf16 v70, v111, v11
  v_dot2c_f32_bf16 v71, v111, v12
  s_waitcnt vmcnt(7)
  buffer_load_dwordx4 v[92:95], v1, s[28:31], s60 offen offset:3072 nt
  v_dot2c_f32_bf16 v72, v112, v11
  v_dot2c_f32_bf16 v73, v112, v12
  v_dot2c_f32_bf16 v74, v113, v11
  v_dot2c_f32_bf16 v75, v113, v12
  v_dot2c_f32_bf16 v76, v114, v11
  v_dot2c_f32_bf16 v77, v114, v12
  v_dot2c_f32_bf16 v78, v115, v11
  v_dot2c_f32_bf16 v79, v115, v12
  s_waitcnt vmcnt(7)
  buffer_load_dwordx4 v[96:99], v1, s[28:31], s60 offen offset:3200 nt
  v_dot2c_f32_bf16 v56, v116, v13
  v_dot2c_f32_bf16 v57, v116, v14
  v_dot2c_f32_bf16 v58, v117, v13
  v_dot2c_f32_bf16 v59, v117, v14
  v_dot2c_f32_bf16 v60, v118, v13
  v_dot2c_f32_bf16 v61, v118, v14
  v_dot2c_f32_bf16 v62, v119, v13
  v_dot2c_f32_bf16 v63, v119, v14
  s_cmp_lg_u32 s3, 0
  s_cbranch_scc1 L_p1ua
  s_waitcnt lgkmcnt(0)
  v_mov_b32 v229, s34
  ds_write_b32 v230, v229 offset:4
  s_waitcnt lgkmcnt(0)
  s_cmp_lt_u32 s34, s15
  s_cbranch_scc1 L_p1ua
  s_mov_b32 s16, 1
  s_atomic_add s16, s[10:11], 0 glc
L_p1ua:
  s_barrier
  ds_read_b32 v229, v230 offset:4
  s_waitcnt vmcnt(7)
  buffer_load_dwordx4 v[100:103], v1, s[28:31], s60 offen offset:3328 nt
  v_dot2c_f32_bf16 v64, v120, v13
  v_dot2c_f32_bf16 v65, v120, v14
  v_dot2c_f32_bf16 v66, v121, v13
  v_dot2c_f32_bf16 v67, v121, v14
  v_dot2c_f32_bf16 v68, v122, v13
  v_dot2c_f32_bf16 v69, v122, v14
  v_dot2c_f32_bf16 v70, v123, v13
  v_dot2c_f32_bf16 v71, v123, v14
  s_waitcnt vmcnt(7)
  v_dot2c_f32_bf16 v72, v124, v13
  v_dot2c_f32_bf16 v73, v124, v14
  v_dot2c_f32_bf16 v74, v125, v13
  v_dot2c_f32_bf16 v75, v125, v14
  v_dot2c_f32_bf16 v76, v126, v13
  v_dot2c_f32_bf16 v77, v126, v14
  v_dot2c_f32_bf16 v78, v127, v13
  v_dot2c_f32_bf16 v79, v127, v14
  s_branch L_db
L_burstb:
  buffer_load_dwordx4 v[104:107], v1, s[28:31], s60 offen offset:0 nt
  s_waitcnt vmcnt(7)
  buffer_load_dwordx4 v[108:111], v1, s[28:31], s60 offen offset:128 nt
  v_lshlrev_b32 v7, 16, v36
  v_and_b32 v8, 0xffff0000, v36
  v_sub_f32 v7, v7, v5
  v_sub_f32 v8, v8, v5
  v_mul_f32 v7, 0x3fb8aa3b, v7
  v_mul_f32 v8, 0x3fb8aa3b, v8
  v_exp_f32 v7, v7
  v_exp_f32 v8, v8
  v_mul_f32 v7, v7, v6
  v_mul_f32 v8, v8, v6
  v_cvt_pk_bf16_f32 v9, v7, v8
  v_and_b32 v11, 0xffff, v9
  v_lshlrev_b32 v12, 16, v9
  v_lshrrev_b32 v13, 16, v9
  v_and_b32 v14, 0xffff0000, v9
  v_dot2c_f32_bf16 v56, v80, v11
  v_dot2c_f32_bf16 v57, v80, v12
  v_dot2c_f32_bf16 v58, v81, v11
  v_dot2c_f32_bf16 v59, v81, v12
  v_dot2c_f32_bf16 v60, v82, v11
  v_dot2c_f32_bf16 v61, v82, v12
  v_dot2c_f32_bf16 v62, v83, v11
  v_dot2c_f32_bf16 v63, v83, v12
  s_cmp_lg_u32 s3, 0
  s_cbranch_scc1 L_p0ub
  s_mov_b32 s34, 1
  s_atomic_add s34, s[32:33], 0 glc
L_p0ub:
  s_waitcnt vmcnt(7)
  buffer_load_dwordx4 v[112:115], v1, s[28:31], s60 offen offset:256 nt
  v_dot2c_f32_bf16 v64, v84, v11
  v_dot2c_f32_bf16 v65, v84, v12
  v_dot2c_f32_bf16 v66, v85, v11
  v_dot2c_f32_bf16 v67, v85, v12
  v_dot2c_f32_bf16 v68, v86, v11
  v_dot2c_f32_bf16 v69, v86, v12
  v_dot2c_f32_bf16 v70, v87, v11
  v_dot2c_f32_bf16 v71, v87, v12
  s_waitcnt vmcnt(7)
  buffer_load_dwordx4 v[116:119], v1, s[28:31], s60 offen offset:3072 nt
  v_dot2c_f32_bf16 v72, v88, v11
  v_dot2c_f32_bf16 v73, v88, v12
  v_dot2c_f32_bf16 v74, v89, v11
  v_dot2c_f32_bf16 v75, v89, v12
  v_dot2c_f32_bf16 v76, v90, v11
  v_dot2c_f32_bf16 v77, v90, v12
  v_dot2c_f32_bf16 v78, v91, v11
  v_dot2c_f32_bf16 v79, v91, v12
  s_waitcnt vmcnt(7)
  buffer_load_dwordx4 v[120:123], v1, s[28:31], s60 offen offset:3200 nt
  v_dot2c_f32_bf16 v56, v92, v13
  v_dot2c_f32_bf16 v57, v92, v14
  v_dot2c_f32_bf16 v58, v93, v13
  v_dot2c_f32_bf16 v59, v93, v14
  v_dot2c_f32_bf16 v60, v94, v13
  v_dot2c_f32_bf16 v61, v94, v14
  v_dot2c_f32_bf16 v62, v95, v13
  v_dot2c_f32_bf16 v63, v95, v14
  s_cmp_lg_u32 s3, 0
  s_cbranch_scc1 L_p1ub
  s_waitcnt lgkmcnt(0)
  v_mov_b32 v229, s34
  ds_write_b32 v230, v229 offset:0
  s_waitcnt lgkmcnt(0)
  s_cmp_lt_u32 s34, s15
  s_cbranch_scc1 L_p1ub
  s_mov_b32 s16, 1
  s_atomic_add s16, s[10:11], 0 glc
L_p1ub:
  s_barrier
  ds_read_b32 v229, v230 offset:0
  s_waitcnt vmcnt(7)
  buffer_load_dwordx4 v[124:127], v1, s[28:31], s60 offen offset:3328 nt
  v_dot2c_f32_bf16 v64, v96, v13
  v_dot2c_f32_bf16 v65, v96, v14
  v_dot2c_f32_bf16 v66, v97, v13
  v_dot2c_f32_bf16 v67, v97, v14
  v_dot2c_f32_bf16 v68, v98, v13
  v_dot2c_f32_bf16 v69, v98, v14
  v_dot2c_f32_bf16 v70, v99, v13
  v_dot2c_f32_bf16 v71, v99, v14
  s_waitcnt vmcnt(7)
  v_dot2c_f32_bf16 v72, v100, v13
  v_dot2c_f32_bf16 v73, v100, v14
  v_dot2c_f32_bf16 v74, v101, v13
  v_dot2c_f32_bf16 v75, v101, v14
  v_dot2c_f32_bf16 v76, v102, v13
  v_dot2c_f32_bf16 v77, v102, v14
  v_dot2c_f32_bf16 v78, v103, v13
  v_dot2c_f32_bf16 v79, v103, v14
  s_branch L_da
L_taila:
  s_cmp_lg_u32 s3, 0
  s_cbranch_scc1 L_tka
  v_mov_b32 v229, s16
  ds_write_b32 v230, v229 offset:8
  s_waitcnt lgkmcnt(0)
L_tka:
  s_barrier
  ds_read_b32 v229, v230 offset:8
  s_mov_b32 exec_lo, 0x000f000f
  s_mov_b32 exec_hi, 0x000f000f
  buffer_store_dwordx4 v[224:227], v228, s[56:59], 0 offen sc1
  s_mov_b64 exec, -1
  s_cmp_ge_u32 s3, 2
  s_cbranch_scc1 L_epa
  ds_read_b128 v[128:131], v18 offset:0
  ds_read_b128 v[132:135], v18 offset:768
  ds_read_b128 v[136:139], v18 offset:1536
  ds_read_b128 v[140:143], v18 offset:2304
  s_mov_b32 exec_hi, 0x0000ffff
  s_waitcnt lgkmcnt(2)
  v_pk_add_f32 v[128:129], v[128:129], v[132:133]
  v_pk_add_f32 v[130:131], v[130:131], v[134:135]
  s_waitcnt lgkmcnt(0)
  v_pk_add_f32 v[136:137], v[136:137], v[140:141]
  v_pk_add_f32 v[138:139], v[138:139], v[142:143]
  v_pk_add_f32 v[128:129], v[128:129], v[136:137]
  v_pk_add_f32 v[130:131], v[130:131], v[138:139]
  v_and_or_b32 v128, v128, -16, s80
  v_and_or_b32 v129, v129, -16, s81
  v_and_or_b32 v130, v130, -16, s82
  v_and_or_b32 v131, v131, -16, s83
  buffer_store_dwordx4 v[128:131], v231, s[48:51], s75 offen sc1
  s_mov_b32 exec_hi, -1
L_epa:
  s_waitcnt lgkmcnt(0)
  v_readfirstlane_b32 s65, v229
  s_and_b32 s66, s2, 7
  s_and_b32 s65, s65, 31
  s_lshl_b32 s65, s65, 3
  s_add_u32 s86, s65, s66
  s_lshr_b32 s65, s86, 3
  s_mul_i32 s66, s65, 52429
  s_lshr_b32 s66, s66, 18
  s_mul_i32 s67, s66, 5
  s_sub_u32 s67, s65, s67
  s_lshl_b32 s66, s66, 3
  s_and_b32 s65, s86, 7
  s_add_u32 s87, s65, s66
  s_mov_b32 s85, s67
  s_lshl_b32 s67, s67, 8
  s_and_b32 s66, s87, 31
  s_mul_i32 s66, s66, 245760
  s_add_u32 s66, s66, s67
  s_cmp_lt_u32 s87, 32
  s_cselect_b32 s40, s12, s18
  s_cselect_b32 s41, s13, s19
  s_cmp_lt_u32 s86, 200
  s_cselect_b32 s42, 244736, 0
  s_cselect_b32 s66, s66, 0
  s_add_u32 s40, s40, s66
  s_addc_u32 s41, s41, 0
  s_mov_b32 s43, 0x00020000
  s_waitcnt vmcnt(6)
  s_mul_i32 s74, s3, 12288
  s_add_u32 m0, s74, 0
  s_mul_i32 s76, s3, 61440
  buffer_load_dwordx4 v2, s[40:43], s76 offen nt lds
  v_lshlrev_b32 v7, 16, v37
  v_and_b32 v8, 0xffff0000, v37
  v_sub_f32 v7, v7, v5
  v_sub_f32 v8, v8, v5
  v_mul_f32 v7, 0x3fb8aa3b, v7
  v_mul_f32 v8, 0x3fb8aa3b, v8
  v_exp_f32 v7, v7
  v_exp_f32 v8, v8
  v_mul_f32 v7, v7, v6
  v_mul_f32 v8, v8, v6
  v_cvt_pk_bf16_f32 v9, v7, v8
  v_and_b32 v11, 0xffff, v9
  v_lshlrev_b32 v12, 16, v9
  v_lshrrev_b32 v13, 16, v9
  v_and_b32 v14, 0xffff0000, v9
  v_dot2c_f32_bf16 v56, v104, v11
  v_dot2c_f32_bf16 v57, v104, v12
  v_dot2c_f32_bf16 v58, v105, v11
  v_dot2c_f32_bf16 v59, v105, v12
  v_dot2c_f32_bf16 v60, v106, v11
  v_dot2c_f32_bf16 v61, v106, v12
  v_dot2c_f32_bf16 v62, v107, v11
  v_dot2c_f32_bf16 v63, v107, v12
  s_waitcnt vmcnt(6)
  s_add_u32 m0, s74, 1024
  s_add_u32 s76, s76, 5120
  buffer_load_dwordx4 v3, s[40:43], s76 offen nt lds
  v_dot2c_f32_bf16 v64, v108, v11
  v_dot2c_f32_bf16 v65, v108, v12
  v_dot2c_f32_bf16 v66, v109, v11
  v_dot2c_f32_bf16 v67, v109, v12
  v_dot2c_f32_bf16 v68, v110, v11
  v_dot2c_f32_bf16 v69, v110, v12
  v_dot2c_f32_bf16 v70, v111, v11
  v_dot2c_f32_bf16 v71, v111, v12
  s_waitcnt vmcnt(6)
  s_add_u32 m0, s74, 2048
  s_add_u32 s76, s76, 5120
  buffer_load_dwordx4 v2, s[40:43], s76 offen nt lds
  v_dot2c_f32_bf16 v72, v112, v11
  v_dot2c_f32_bf16 v73, v112, v12
  v_dot2c_f32_bf16 v74, v113, v11
  v_dot2c_f32_bf16 v75, v113, v12
  v_dot2c_f32_bf16 v76, v114, v11
  v_dot2c_f32_bf16 v77, v114, v12
  v_dot2c_f32_bf16 v78, v115, v11
  v_dot2c_f32_bf16 v79, v115, v12
  s_waitcnt vmcnt(6)
  s_add_u32 m0, s74, 3072
  s_add_u32 s76, s76, 5120
  buffer_load_dwordx4 v3, s[40:43], s76 offen nt lds
  v_dot2c_f32_bf16 v56, v116, v13
  v_dot2c_f32_bf16 v57, v116, v14
  v_dot2c_f32_bf16 v58, v117, v13
  v_dot2c_f32_bf16 v59, v117, v14
  v_dot2c_f32_bf16 v60, v118, v13
  v_dot2c_f32_bf16 v61, v118, v14
  v_dot2c_f32_bf16 v62, v119, v13
  v_dot2c_f32_bf16 v63, v119, v14
  s_nop 1
  s_nop 0
  v_permlane32_swap_b32 v56, v60
  v_permlane32_swap_b32 v57, v61
  v_permlane32_swap_b32 v58, v62
  v_permlane32_swap_b32 v59, v63
  v_add_f32 v56, v56, v60
  v_add_f32 v58, v58, v62
  v_add_f32 v57, v57, v61
  v_add_f32 v59, v59, v63
  v_permlane16_swap_b32 v56, v58
  s_nop 0
  v_permlane16_swap_b32 v57, v59
  v_add_f32 v56, v56, v58
  v_add_f32 v57, v57, v59
  s_nop 0
  v_add_f32_dpp v58, v56, v56 row_ror:8 row_mask:0xf bank_mask:0x3
  v_add_f32_dpp v58, v57, v57 row_ror:8 row_mask:0xf bank_mask:0xc
  ds_write_b32 v41, v58 offset:0
  s_waitcnt vmcnt(6)
  s_add_u32 m0, s74, 4096
  s_add_u32 s76, s76, 5120
  buffer_load_dwordx4 v2, s[40:43], s76 offen nt lds
  v_dot2c_f32_bf16 v64, v120, v13
  v_dot2c_f32_bf16 v65, v120, v14
  v_dot2c_f32_bf16 v66, v121, v13
  v_dot2c_f32_bf16 v67, v121, v14
  v_dot2c_f32_bf16 v68, v122, v13
  v_dot2c_f32_bf16 v69, v122, v14
  v_dot2c_f32_bf16 v70, v123, v13
  v_dot2c_f32_bf16 v71, v123, v14
  s_nop 1
  s_nop 0
  v_permlane32_swap_b32 v64, v68
  v_permlane32_swap_b32 v65, v69
  v_permlane32_swap_b32 v66, v70
  v_permlane32_swap_b32 v67, v71
  v_add_f32 v64, v64, v68
  v_add_f32 v66, v66, v70
  v_add_f32 v65, v65, v69
  v_add_f32 v67, v67, v71
  v_permlane16_swap_b32 v64, v66
  s_nop 0
  v_permlane16_swap_b32 v65, v67
  v_add_f32 v64, v64, v66
  v_add_f32 v65, v65, v67
  s_nop 0
  v_add_f32_dpp v66, v64, v64 row_ror:8 row_mask:0xf bank_mask:0x3
  v_add_f32_dpp v66, v65, v65 row_ror:8 row_mask:0xf bank_mask:0xc
  ds_write_b32 v41, v66 offset:256
  s_waitcnt vmcnt(6)
  v_dot2c_f32_bf16 v72, v124, v13
  v_dot2c_f32_bf16 v73, v124, v14
  v_dot2c_f32_bf16 v74, v125, v13
  v_dot2c_f32_bf16 v75, v125, v14
  v_dot2c_f32_bf16 v76, v126, v13
  v_dot2c_f32_bf16 v77, v126, v14
  v_dot2c_f32_bf16 v78, v127, v13
  v_dot2c_f32_bf16 v79, v127, v14
  s_branch L_tail
L_tailb:
  s_cmp_lg_u32 s3, 0
  s_cbranch_scc1 L_tkb
  v_mov_b32 v229, s16
  ds_write_b32 v230, v229 offset:8
  s_waitcnt lgkmcnt(0)
L_tkb:
  s_barrier
  ds_read_b32 v229, v230 offset:8
  s_mov_b32 exec_lo, 0x000f000f
  s_mov_b32 exec_hi, 0x000f000f
  buffer_store_dwordx4 v[224:227], v228, s[56:59], 0 offen sc1
  s_mov_b64 exec, -1
  s_cmp_ge_u32 s3, 2
  s_cbranch_scc1 L_epb
  ds_read_b128 v[128:131], v18 offset:0
  ds_read_b128 v[132:135], v18 offset:768
  ds_read_b128 v[136:139], v18 offset:1536
  ds_read_b128 v[140:143], v18 offset:2304
  s_mov_b32 exec_hi, 0x0000ffff
  s_waitcnt lgkmcnt(2)
  v_pk_add_f32 v[128:129], v[128:129], v[132:133]
  v_pk_add_f32 v[130:131], v[130:131], v[134:135]
  s_waitcnt lgkmcnt(0)
  v_pk_add_f32 v[136:137], v[136:137], v[140:141]
  v_pk_add_f32 v[138:139], v[138:139], v[142:143]
  v_pk_add_f32 v[128:129], v[128:129], v[136:137]
  v_pk_add_f32 v[130:131], v[130:131], v[138:139]
  v_and_or_b32 v128, v128, -16, s80
  v_and_or_b32 v129, v129, -16, s81
  v_and_or_b32 v130, v130, -16, s82
  v_and_or_b32 v131, v131, -16, s83
  buffer_store_dwordx4 v[128:131], v231, s[48:51], s75 offen sc1
  s_mov_b32 exec_hi, -1
L_epb:
  s_waitcnt lgkmcnt(0)
  v_readfirstlane_b32 s65, v229
  s_and_b32 s66, s2, 7
  s_and_b32 s65, s65, 31
  s_lshl_b32 s65, s65, 3
  s_add_u32 s86, s65, s66
  s_lshr_b32 s65, s86, 3
  s_mul_i32 s66, s65, 52429
  s_lshr_b32 s66, s66, 18
  s_mul_i32 s67, s66, 5
  s_sub_u32 s67, s65, s67
  s_lshl_b32 s66, s66, 3
  s_and_b32 s65, s86, 7
  s_add_u32 s87, s65, s66
  s_mov_b32 s85, s67
  s_lshl_b32 s67, s67, 8
  s_and_b32 s66, s87, 31
  s_mul_i32 s66, s66, 245760
  s_add_u32 s66, s66, s67
  s_cmp_lt_u32 s87, 32
  s_cselect_b32 s40, s12, s18
  s_cselect_b32 s41, s13, s19
  s_cmp_lt_u32 s86, 200
  s_cselect_b32 s42, 244736, 0
  s_cselect_b32 s66, s66, 0
  s_add_u32 s40, s40, s66
  s_addc_u32 s41, s41, 0
  s_mov_b32 s43, 0x00020000
  s_waitcnt vmcnt(6)
  s_mul_i32 s74, s3, 12288
  s_add_u32 m0, s74, 0
  s_mul_i32 s76, s3, 61440
  buffer_load_dwordx4 v2, s[40:43], s76 offen nt lds
  v_lshlrev_b32 v7, 16, v36
  v_and_b32 v8, 0xffff0000, v36
  v_sub_f32 v7, v7, v5
  v_sub_f32 v8, v8, v5
  v_mul_f32 v7, 0x3fb8aa3b, v7
  v_mul_f32 v8, 0x3fb8aa3b, v8
  v_exp_f32 v7, v7
  v_exp_f32 v8, v8
  v_mul_f32 v7, v7, v6
  v_mul_f32 v8, v8, v6
  v_cvt_pk_bf16_f32 v9, v7, v8
  v_and_b32 v11, 0xffff, v9
  v_lshlrev_b32 v12, 16, v9
  v_lshrrev_b32 v13, 16, v9
  v_and_b32 v14, 0xffff0000, v9
  v_dot2c_f32_bf16 v56, v80, v11
  v_dot2c_f32_bf16 v57, v80, v12
  v_dot2c_f32_bf16 v58, v81, v11
  v_dot2c_f32_bf16 v59, v81, v12
  v_dot2c_f32_bf16 v60, v82, v11
  v_dot2c_f32_bf16 v61, v82, v12
  v_dot2c_f32_bf16 v62, v83, v11
  v_dot2c_f32_bf16 v63, v83, v12
  s_waitcnt vmcnt(6)
  s_add_u32 m0, s74, 1024
  s_add_u32 s76, s76, 5120
  buffer_load_dwordx4 v3, s[40:43], s76 offen nt lds
  v_dot2c_f32_bf16 v64, v84, v11
  v_dot2c_f32_bf16 v65, v84, v12
  v_dot2c_f32_bf16 v66, v85, v11
  v_dot2c_f32_bf16 v67, v85, v12
  v_dot2c_f32_bf16 v68, v86, v11
  v_dot2c_f32_bf16 v69, v86, v12
  v_dot2c_f32_bf16 v70, v87, v11
  v_dot2c_f32_bf16 v71, v87, v12
  s_waitcnt vmcnt(6)
  s_add_u32 m0, s74, 2048
  s_add_u32 s76, s76, 5120
  buffer_load_dwordx4 v2, s[40:43], s76 offen nt lds
  v_dot2c_f32_bf16 v72, v88, v11
  v_dot2c_f32_bf16 v73, v88, v12
  v_dot2c_f32_bf16 v74, v89, v11
  v_dot2c_f32_bf16 v75, v89, v12
  v_dot2c_f32_bf16 v76, v90, v11
  v_dot2c_f32_bf16 v77, v90, v12
  v_dot2c_f32_bf16 v78, v91, v11
  v_dot2c_f32_bf16 v79, v91, v12
  s_waitcnt vmcnt(6)
  s_add_u32 m0, s74, 3072
  s_add_u32 s76, s76, 5120
  buffer_load_dwordx4 v3, s[40:43], s76 offen nt lds
  v_dot2c_f32_bf16 v56, v92, v13
  v_dot2c_f32_bf16 v57, v92, v14
  v_dot2c_f32_bf16 v58, v93, v13
  v_dot2c_f32_bf16 v59, v93, v14
  v_dot2c_f32_bf16 v60, v94, v13
  v_dot2c_f32_bf16 v61, v94, v14
  v_dot2c_f32_bf16 v62, v95, v13
  v_dot2c_f32_bf16 v63, v95, v14
  s_nop 1
  s_nop 0
  v_permlane32_swap_b32 v56, v60
  v_permlane32_swap_b32 v57, v61
  v_permlane32_swap_b32 v58, v62
  v_permlane32_swap_b32 v59, v63
  v_add_f32 v56, v56, v60
  v_add_f32 v58, v58, v62
  v_add_f32 v57, v57, v61
  v_add_f32 v59, v59, v63
  v_permlane16_swap_b32 v56, v58
  s_nop 0
  v_permlane16_swap_b32 v57, v59
  v_add_f32 v56, v56, v58
  v_add_f32 v57, v57, v59
  s_nop 0
  v_add_f32_dpp v58, v56, v56 row_ror:8 row_mask:0xf bank_mask:0x3
  v_add_f32_dpp v58, v57, v57 row_ror:8 row_mask:0xf bank_mask:0xc
  ds_write_b32 v41, v58 offset:0
  s_waitcnt vmcnt(6)
  s_add_u32 m0, s74, 4096
  s_add_u32 s76, s76, 5120
  buffer_load_dwordx4 v2, s[40:43], s76 offen nt lds
  v_dot2c_f32_bf16 v64, v96, v13
  v_dot2c_f32_bf16 v65, v96, v14
  v_dot2c_f32_bf16 v66, v97, v13
  v_dot2c_f32_bf16 v67, v97, v14
  v_dot2c_f32_bf16 v68, v98, v13
  v_dot2c_f32_bf16 v69, v98, v14
  v_dot2c_f32_bf16 v70, v99, v13
  v_dot2c_f32_bf16 v71, v99, v14
  s_nop 1
  s_nop 0
  v_permlane32_swap_b32 v64, v68
  v_permlane32_swap_b32 v65, v69
  v_permlane32_swap_b32 v66, v70
  v_permlane32_swap_b32 v67, v71
  v_add_f32 v64, v64, v68
  v_add_f32 v66, v66, v70
  v_add_f32 v65, v65, v69
  v_add_f32 v67, v67, v71
  v_permlane16_swap_b32 v64, v66
  s_nop 0
  v_permlane16_swap_b32 v65, v67
  v_add_f32 v64, v64, v66
  v_add_f32 v65, v65, v67
  s_nop 0
  v_add_f32_dpp v66, v64, v64 row_ror:8 row_mask:0xf bank_mask:0x3
  v_add_f32_dpp v66, v65, v65 row_ror:8 row_mask:0xf bank_mask:0xc
  ds_write_b32 v41, v66 offset:256
  s_waitcnt vmcnt(6)
  v_dot2c_f32_bf16 v72, v100, v13
  v_dot2c_f32_bf16 v73, v100, v14
  v_dot2c_f32_bf16 v74, v101, v13
  v_dot2c_f32_bf16 v75, v101, v14
  v_dot2c_f32_bf16 v76, v102, v13
  v_dot2c_f32_bf16 v77, v102, v14
  v_dot2c_f32_bf16 v78, v103, v13
  v_dot2c_f32_bf16 v79, v103, v14
L_tail:
  s_nop 1
  s_nop 0
  v_permlane32_swap_b32 v72, v76
  v_permlane32_swap_b32 v73, v77
  v_permlane32_swap_b32 v74, v78
  v_permlane32_swap_b32 v75, v79
  v_add_f32 v72, v72, v76
  v_add_f32 v74, v74, v78
  v_add_f32 v73, v73, v77
  v_add_f32 v75, v75, v79
  v_permlane16_swap_b32 v72, v74
  s_nop 0
  v_permlane16_swap_b32 v73, v75
  v_add_f32 v72, v72, v74
  v_add_f32 v73, v73, v75
  s_nop 0
  v_add_f32_dpp v74, v72, v72 row_ror:8 row_mask:0xf bank_mask:0x3
  v_add_f32_dpp v74, v73, v73 row_ror:8 row_mask:0xf bank_mask:0xc
  ds_write_b32 v41, v74 offset:512
  s_lshl_b32 s70, s3, 5
  s_add_u32 s70, s70, s87
  s_cmp_lg_u32 s3, 2
  s_waitcnt lgkmcnt(0)
  s_barrier
  s_cbranch_scc1 L_nopub
  s_setprio 3
  ds_read_b128 v[128:131], v18 offset:0
  ds_read_b128 v[132:135], v18 offset:768
  ds_read_b128 v[136:139], v18 offset:1536
  ds_read_b128 v[140:143], v18 offset:2304
  s_mov_b32 exec_hi, 0x0000ffff
  s_waitcnt lgkmcnt(2)
  v_pk_add_f32 v[128:129], v[128:129], v[132:133]
  v_pk_add_f32 v[130:131], v[130:131], v[134:135]
  s_waitcnt lgkmcnt(0)
  v_pk_add_f32 v[136:137], v[136:137], v[140:141]
  v_pk_add_f32 v[138:139], v[138:139], v[142:143]
  v_pk_add_f32 v[128:129], v[128:129], v[136:137]
  v_pk_add_f32 v[130:131], v[130:131], v[138:139]
  v_and_or_b32 v128, v128, -16, s80
  v_and_or_b32 v129, v129, -16, s81
  v_and_or_b32 v130, v130, -16, s82
  v_and_or_b32 v131, v131, -16, s83
  buffer_store_dwordx4 v[128:131], v231, s[48:51], s75 offen sc1
  s_mov_b32 exec_hi, -1
  s_setprio 0
L_nopub:
  s_cmp_ge_u32 s86, 200
  s_cbranch_scc1 L_stage3
  s_add_u32 m0, s74, 5120
  s_add_u32 s76, s76, 5120
  buffer_load_dwordx4 v3, s[40:43], s76 offen nt lds
  s_add_u32 m0, s74, 6144
  s_add_u32 s76, s76, 5120
  buffer_load_dwordx4 v2, s[40:43], s76 offen nt lds
  s_add_u32 m0, s74, 7168
  s_add_u32 s76, s76, 5120
  buffer_load_dwordx4 v3, s[40:43], s76 offen nt lds
  s_add_u32 m0, s74, 8192
  s_add_u32 s76, s76, 5120
  buffer_load_dwordx4 v2, s[40:43], s76 offen nt lds
  s_add_u32 m0, s74, 9216
  s_add_u32 s76, s76, 5120
  buffer_load_dwordx4 v3, s[40:43], s76 offen nt lds
  s_add_u32 m0, s74, 10240
  s_add_u32 s76, s76, 5120
  buffer_load_dwordx4 v2, s[40:43], s76 offen nt lds
  s_add_u32 m0, s74, 11264
  s_add_u32 s76, s76, 5120
  buffer_load_dwordx4 v3, s[40:43], s76 offen nt lds
  s_cmp_ge_u32 s87, 32
  s_cbranch_scc1 L_ffn
  s_and_b32 s65, s70, 0x43
  s_bfe_u32 s66, s70, 0x30003
  s_lshl_b32 s66, s66, 2
  s_or_b32 s65, s65, s66
  s_bfe_u32 s66, s70, 0x10002
  s_xor_b32 s66, s66, s14
  s_lshl_b32 s66, s66, 5
  s_or_b32 s65, s65, s66
  v_lshrrev_b32 v9, 8, v16
  v_mov_b32 v231, s65
  v_lshl_add_u32 v231, v9, 7, v231
  v_and_b32 v9, 255, v16
  v_lshl_add_u32 v231, v231, 8, v9
  s_add_u32 s71, s70, 1
  s_and_b32 s71, s71, 2
  s_lshl_b32 s71, s71, 1
  s_add_u32 s71, s71, 4
  s_cmp_ge_u32 s70, 86
  s_cselect_b32 s71, 6, s71
  s_mov_b32 s88, 786432
  s_mov_b32 s89, 884736
  s_mov_b32 s90, 983040
  s_mov_b32 s91, 1081344
  s_mov_b32 s92, 1179648
  s_mov_b32 s93, 1277952
  s_mov_b32 s94, 1376256
  s_mov_b32 s95, 1474560
  s_mul_i32 s66, s3, 448
  v_lshrrev_b32 v9, 7, v16
  v_lshl_add_u32 v18, v9, 6, s66
  v_and_b32 v9, 48, v16
  v_add_u32 v18, v9, v18
  v_bfe_u32 v9, v16, 6, 1
  v_lshl_add_u32 v18, v9, 3, v18
  v_lshrrev_b32 v9, 4, v4
  v_bfe_u32 v10, v4, 2, 2
  v_lshl_add_u32 v7, v9, 2, v10
  v_and_b32 v8, 7, v7
  s_lshl_b32 s66, s3, 1
  v_xor_b32 v8, s66, v8
  v_lshlrev_b32 v8, 5, v8
  v_lshl_add_u32 v8, v7, 8, v8
  v_and_b32 v10, 3, v4
  v_lshl_add_u32 v2, v10, 3, v8
  v_xor_b32 v3, 32, v2
  v_mul_u32_u24 v19, 448, v10
  v_lshl_add_u32 v19, v9, 4, v19
  v_add_u32 v19, 55680, v19
  s_add_u32 s66, s3, s87
  v_and_b32 v7, 2, v10
  v_lshl_add_u32 v7, v7, 1, s66
  v_and_b32 v7, 7, v7
  v_lshlrev_b32 v42, 7, v7
  v_xor_b32 v7, s14, v10
  v_and_b32 v7, 1, v7
  v_lshl_add_u32 v42, v7, 13, v42
  v_lshl_add_u32 v42, v9, 4, v42
  v_and_b32 v7, 4, v4
  v_lshl_add_u32 v42, v7, 4, v42
  v_cmp_ne_u32 s[68:69], 0, v7
  s_mul_i32 s73, s85, 5
  s_lshr_b32 s66, s87, 3
  s_add_u32 s73, s73, s66
  s_lshl_b32 s73, s73, 4
  s_and_b32 s66, s87, 7
  s_add_u32 s73, s73, s66
  s_lshl_b32 s73, s73, 10
  s_add_u32 s73, s73, 1572864
  s_cmp_eq_u32 s71, 4
  s_cbranch_scc1 L_g4
  s_cmp_eq_u32 s71, 8
  s_cbranch_scc1 L_g8
L_g6:
  s_waitcnt vmcnt(2)
  buffer_load_dwordx4 v[144:147], v231, s[48:51], s88 offen sc1
  buffer_load_dwordx4 v[148:151], v231, s[48:51], s89 offen sc1
  buffer_load_dwordx4 v[152:155], v231, s[48:51], s90 offen sc1
  buffer_load_dwordx4 v[156:159], v231, s[48:51], s91 offen sc1
  buffer_load_dwordx4 v[160:163], v231, s[48:51], s92 offen sc1
  buffer_load_dwordx4 v[164:167], v231, s[48:51], s93 offen sc1
  s_waitcnt vmcnt(5)
  v_xor_b32 v144, s80, v144
  v_xor_b32 v145, s81, v145
  v_xor_b32 v146, s82, v146
  v_xor_b32 v147, s83, v147
  v_or_b32 v7, v144, v145
  v_or3_b32 v7, v146, v147, v7
  s_waitcnt vmcnt(4)
  v_xor_b32 v148, s80, v148
  v_xor_b32 v149, s81, v149
  v_xor_b32 v150, s82, v150
  v_xor_b32 v151, s83, v151
  v_or3_b32 v7, v148, v149, v7
  v_or3_b32 v7, v150, v151, v7
  v_pk_add_f32 v[144:145], v[144:145], v[148:149]
  v_pk_add_f32 v[146:147], v[146:147], v[150:151]
  s_waitcnt vmcnt(3)
  v_xor_b32 v152, s80, v152
  v_xor_b32 v153, s81, v153
  v_xor_b32 v154, s82, v154
  v_xor_b32 v155, s83, v155
  v_or3_b32 v7, v152, v153, v7
  v_or3_b32 v7, v154, v155, v7
  v_pk_add_f32 v[144:145], v[144:145], v[152:153]
  v_pk_add_f32 v[146:147], v[146:147], v[154:155]
  s_waitcnt vmcnt(2)
  v_xor_b32 v156, s80, v156
  v_xor_b32 v157, s81, v157
  v_xor_b32 v158, s82, v158
  v_xor_b32 v159, s83, v159
  v_or3_b32 v7, v156, v157, v7
  v_or3_b32 v7, v158, v159, v7
  v_pk_add_f32 v[144:145], v[144:145], v[156:157]
  v_pk_add_f32 v[146:147], v[146:147], v[158:159]
  s_waitcnt vmcnt(1)
  v_xor_b32 v160, s80, v160
  v_xor_b32 v161, s81, v161
  v_xor_b32 v162, s82, v162
  v_xor_b32 v163, s83, v163
  v_or3_b32 v7, v160, v161, v7
  v_or3_b32 v7, v162, v163, v7
  v_pk_add_f32 v[144:145], v[144:145], v[160:161]
  v_pk_add_f32 v[146:147], v[146:147], v[162:163]
  s_waitcnt vmcnt(0)
  v_xor_b32 v164, s80, v164
  v_xor_b32 v165, s81, v165
  v_xor_b32 v166, s82, v166
  v_xor_b32 v167, s83, v167
  v_or3_b32 v7, v164, v165, v7
  v_or3_b32 v7, v166, v167, v7
  v_pk_add_f32 v[144:145], v[144:145], v[164:165]
  v_pk_add_f32 v[146:147], v[146:147], v[166:167]
  v_and_b32 v7, 15, v7
  v_cmp_ne_u32 vcc, 0, v7
  v_cvt_pk_bf16_f32 v20, v144, v145
  v_cvt_pk_bf16_f32 v21, v146, v147
  s_cbranch_vccz L_ook
L_gl6:
  buffer_load_dwordx4 v[144:147], v231, s[48:51], s88 offen sc1
  buffer_load_dwordx4 v[148:151], v231, s[48:51], s89 offen sc1
  buffer_load_dwordx4 v[152:155], v231, s[48:51], s90 offen sc1
  buffer_load_dwordx4 v[156:159], v231, s[48:51], s91 offen sc1
  buffer_load_dwordx4 v[160:163], v231, s[48:51], s92 offen sc1
  buffer_load_dwordx4 v[164:167], v231, s[48:51], s93 offen sc1
  s_waitcnt vmcnt(5)
  v_xor_b32 v144, s80, v144
  v_xor_b32 v145, s81, v145
  v_xor_b32 v146, s82, v146
  v_xor_b32 v147, s83, v147
  v_or_b32 v7, v144, v145
  v_or3_b32 v7, v146, v147, v7
  s_waitcnt vmcnt(4)
  v_xor_b32 v148, s80, v148
  v_xor_b32 v149, s81, v149
  v_xor_b32 v150, s82, v150
  v_xor_b32 v151, s83, v151
  v_or3_b32 v7, v148, v149, v7
  v_or3_b32 v7, v150, v151, v7
  v_pk_add_f32 v[144:145], v[144:145], v[148:149]
  v_pk_add_f32 v[146:147], v[146:147], v[150:151]
  s_waitcnt vmcnt(3)
  v_xor_b32 v152, s80, v152
  v_xor_b32 v153, s81, v153
  v_xor_b32 v154, s82, v154
  v_xor_b32 v155, s83, v155
  v_or3_b32 v7, v152, v153, v7
  v_or3_b32 v7, v154, v155, v7
  v_pk_add_f32 v[144:145], v[144:145], v[152:153]
  v_pk_add_f32 v[146:147], v[146:147], v[154:155]
  s_waitcnt vmcnt(2)
  v_xor_b32 v156, s80, v156
  v_xor_b32 v157, s81, v157
  v_xor_b32 v158, s82, v158
  v_xor_b32 v159, s83, v159
  v_or3_b32 v7, v156, v157, v7
  v_or3_b32 v7, v158, v159, v7
  v_pk_add_f32 v[144:145], v[144:145], v[156:157]
  v_pk_add_f32 v[146:147], v[146:147], v[158:159]
  s_waitcnt vmcnt(1)
  v_xor_b32 v160, s80, v160
  v_xor_b32 v161, s81, v161
  v_xor_b32 v162, s82, v162
  v_xor_b32 v163, s83, v163
  v_or3_b32 v7, v160, v161, v7
  v_or3_b32 v7, v162, v163, v7
  v_pk_add_f32 v[144:145], v[144:145], v[160:161]
  v_pk_add_f32 v[146:147], v[146:147], v[162:163]
  s_waitcnt vmcnt(0)
  v_xor_b32 v164, s80, v164
  v_xor_b32 v165, s81, v165
  v_xor_b32 v166, s82, v166
  v_xor_b32 v167, s83, v167
  v_or3_b32 v7, v164, v165, v7
  v_or3_b32 v7, v166, v167, v7
  v_pk_add_f32 v[144:145], v[144:145], v[164:165]
  v_pk_add_f32 v[146:147], v[146:147], v[166:167]
  v_and_b32 v7, 15, v7
  v_cmp_ne_u32 vcc, 0, v7
  v_cvt_pk_bf16_f32 v20, v144, v145
  v_cvt_pk_bf16_f32 v21, v146, v147
  s_cbranch_vccz L_ook
  s_sub_u32 s77, s77, 1
  s_cbranch_scc0 L_gl6
  s_branch L_end
L_ook:
  ds_write_b64 v18, v[20:21] offset:55680
  s_branch L_proj3
L_ffn:
  v_and_b32 v10, 7, v4
  v_lshrrev_b32 v7, 2, v10
  v_lshrrev_b32 v9, 5, v4
  v_bfe_u32 v8, v4, 3, 2
  v_lshl_add_u32 v40, v9, 1, v7
  v_add_u32 v16, 4, v7
  v_mul_u32_u24 v40, 256, v40
  v_mul_u32_u24 v16, 256, v16
  v_mul_u32_u24 v7, 7, v7
  v_xor_b32 v7, v7, v10
  v_mul_u32_u24 v10, 1536, v8
  v_lshl_add_u32 v10, v7, 4, v10
  v_add_u32 v40, v40, v10
  v_add_u32 v16, v16, v10
  s_mul_i32 s70, s87, 6144
  s_add_u32 s70, s70, 262144
  s_lshl_b32 s66, s3, 6
  s_add_u32 s70, s70, s66
  s_mov_b32 s71, s70
  s_waitcnt vmcnt(2)
  buffer_load_dwordx4 v[144:147], v40, s[48:51], s70 offen sc1
  buffer_load_dwordx4 v[148:151], v16, s[48:51], s71 offen sc1
  v_lshrrev_b32 v10, 1, v8
  v_lshlrev_b32 v18, 6, v10
  v_and_b32 v10, 1, v8
  v_lshl_add_u32 v18, v10, 3, v18
  v_lshl_add_u32 v18, v7, 4, v18
  s_mul_i32 s66, s3, 448
  v_add_u32 v18, s66, v18
  v_lshl_add_u32 v41, v9, 7, v18
  v_lshrrev_b32 v9, 4, v4
  v_bfe_u32 v10, v4, 2, 2
  v_lshl_add_u32 v7, v9, 2, v10
  v_and_b32 v8, 7, v7
  s_lshl_b32 s66, s3, 1
  v_xor_b32 v8, s66, v8
  v_lshlrev_b32 v8, 5, v8
  v_lshl_add_u32 v8, v7, 8, v8
  v_and_b32 v10, 3, v4
  v_lshl_add_u32 v2, v10, 3, v8
  v_xor_b32 v3, 32, v2
  v_mul_u32_u24 v19, 448, v10
  v_lshl_add_u32 v19, v9, 4, v19
  v_add_u32 v19, 55680, v19
  s_add_u32 s66, s3, s87
  v_and_b32 v7, 2, v10
  v_lshl_add_u32 v7, v7, 1, s66
  v_and_b32 v7, 7, v7
  v_lshlrev_b32 v42, 7, v7
  v_xor_b32 v7, s14, v10
  v_and_b32 v7, 1, v7
  v_lshl_add_u32 v42, v7, 13, v42
  v_lshl_add_u32 v42, v9, 4, v42
  v_and_b32 v7, 4, v4
  v_lshl_add_u32 v42, v7, 4, v42
  v_cmp_ne_u32 s[68:69], 0, v7
  s_mul_i32 s73, s85, 5
  s_lshr_b32 s66, s87, 3
  s_add_u32 s73, s73, s66
  s_lshl_b32 s73, s73, 4
  s_and_b32 s66, s87, 7
  s_add_u32 s73, s73, s66
  s_lshl_b32 s73, s73, 10
  s_add_u32 s73, s73, 1572864
  s_waitcnt vmcnt(0)
  s_branch L_hchk
L_hpoll:
  buffer_load_dwordx4 v[144:147], v40, s[48:51], s70 offen sc1
  buffer_load_dwordx4 v[148:151], v16, s[48:51], s71 offen sc1
  s_sub_u32 s77, s77, 1
  s_cbranch_scc1 L_end
  s_waitcnt vmcnt(0)
L_hchk:
  v_xor_b32 v144, s80, v144
  v_xor_b32 v145, s81, v145
  v_xor_b32 v146, s82, v146
  v_xor_b32 v147, s83, v147
  v_or_b32 v7, v144, v145
  v_or3_b32 v7, v146, v147, v7
  v_xor_b32 v148, s80, v148
  v_xor_b32 v149, s81, v149
  v_xor_b32 v150, s82, v150
  v_xor_b32 v151, s83, v151
  v_or3_b32 v7, v148, v149, v7
  v_or3_b32 v7, v150, v151, v7
  v_and_b32 v7, 15, v7
  v_cmp_ne_u32 vcc, 0, v7
  s_nop 1
  s_cbranch_vccnz L_hpoll
  v_add_f32_dpp v144, v144, v144 row_half_mirror row_mask:0xf bank_mask:0xf
  v_add_f32_dpp v145, v145, v145 row_half_mirror row_mask:0xf bank_mask:0xf
  v_add_f32_dpp v146, v146, v146 row_half_mirror row_mask:0xf bank_mask:0xf
  v_add_f32_dpp v147, v147, v147 row_half_mirror row_mask:0xf bank_mask:0xf
  v_add_f32_dpp v148, v148, v148 row_half_mirror row_mask:0xf bank_mask:0xf
  v_add_f32_dpp v149, v149, v149 row_half_mirror row_mask:0xf bank_mask:0xf
  v_add_f32_dpp v150, v150, v150 row_half_mirror row_mask:0xf bank_mask:0xf
  v_add_f32_dpp v151, v151, v151 row_half_mirror row_mask:0xf bank_mask:0xf
  v_max_f32 v144, 0, v144
  v_max_f32 v145, 0, v145
  v_max_f32 v146, 0, v146
  v_max_f32 v147, 0, v147
  v_max_f32 v148, 0, v148
  v_max_f32 v149, 0, v149
  v_max_f32 v150, 0, v150
  v_max_f32 v151, 0, v151
  v_cvt_pk_bf16_f32 v144, v144, v145
  v_cvt_pk_bf16_f32 v145, v146, v147
  v_cvt_pk_bf16_f32 v148, v148, v149
  v_cvt_pk_bf16_f32 v149, v150, v151
  ds_write_b64 v41, v[144:145] offset:55680
  ds_write_b64 v18, v[148:149] offset:55936
L_proj3:
  s_waitcnt lgkmcnt(0)
  s_barrier
  ds_read_b128 v[176:179], v19 offset:0
  ds_read_b64_tr_b16 v[80:81], v2 offset:0
  ds_read_b64_tr_b16 v[82:83], v2 offset:4096
  ds_read_b64_tr_b16 v[84:85], v3 offset:0
  ds_read_b64_tr_b16 v[86:87], v3 offset:4096
  ds_read_b128 v[180:183], v19 offset:64
  ds_read_b64_tr_b16 v[88:89], v2 offset:8192
  ds_read_b64_tr_b16 v[90:91], v2 offset:12288
  ds_read_b64_tr_b16 v[92:93], v3 offset:8192
  ds_read_b64_tr_b16 v[94:95], v3 offset:12288
  ds_read_b128 v[184:187], v19 offset:128
  ds_read_b64_tr_b16 v[96:97], v2 offset:16384
  ds_read_b64_tr_b16 v[98:99], v2 offset:20480
  ds_read_b64_tr_b16 v[100:101], v3 offset:16384
  ds_read_b64_tr_b16 v[102:103], v3 offset:20480
  s_waitcnt lgkmcnt(10)
  v_mfma_f32_16x16x32_bf16 v[200:203], v[80:83], v[176:179], 0
  v_mfma_f32_16x16x32_bf16 v[204:207], v[84:87], v[176:179], 0
  ds_read_b128 v[188:191], v19 offset:192
  ds_read_b64_tr_b16 v[104:105], v2 offset:24576
  ds_read_b64_tr_b16 v[106:107], v2 offset:28672
  ds_read_b64_tr_b16 v[108:109], v3 offset:24576
  ds_read_b64_tr_b16 v[110:111], v3 offset:28672
  s_waitcnt lgkmcnt(10)
  v_mfma_f32_16x16x32_bf16 v[200:203], v[88:91], v[180:183], v[200:203]
  v_mfma_f32_16x16x32_bf16 v[204:207], v[92:95], v[180:183], v[204:207]
  ds_read_b128 v[192:195], v19 offset:256
  ds_read_b64_tr_b16 v[112:113], v2 offset:32768
  ds_read_b64_tr_b16 v[114:115], v2 offset:36864
  ds_read_b64_tr_b16 v[116:117], v3 offset:32768
  ds_read_b64_tr_b16 v[118:119], v3 offset:36864
  s_waitcnt lgkmcnt(10)
  v_mfma_f32_16x16x32_bf16 v[200:203], v[96:99], v[184:187], v[200:203]
  v_mfma_f32_16x16x32_bf16 v[204:207], v[100:103], v[184:187], v[204:207]
  ds_read_b128 v[196:199], v19 offset:320
  ds_read_b64_tr_b16 v[120:121], v2 offset:40960
  ds_read_b64_tr_b16 v[122:123], v2 offset:45056
  ds_read_b64_tr_b16 v[124:125], v3 offset:40960
  ds_read_b64_tr_b16 v[126:127], v3 offset:45056
  s_waitcnt lgkmcnt(10)
  v_mfma_f32_16x16x32_bf16 v[200:203], v[104:107], v[188:191], v[200:203]
  v_mfma_f32_16x16x32_bf16 v[204:207], v[108:111], v[188:191], v[204:207]
  s_waitcnt lgkmcnt(5)
  v_mfma_f32_16x16x32_bf16 v[200:203], v[112:115], v[192:195], v[200:203]
  v_mfma_f32_16x16x32_bf16 v[204:207], v[116:119], v[192:195], v[204:207]
  s_waitcnt lgkmcnt(0)
  v_mfma_f32_16x16x32_bf16 v[200:203], v[120:123], v[196:199], v[200:203]
  v_mfma_f32_16x16x32_bf16 v[204:207], v[124:127], v[196:199], v[204:207]
  s_mov_b32 exec_lo, 0x00ff00ff
  s_mov_b32 exec_hi, 0x00ff00ff
  s_nop 5
  v_cndmask_b32 v200, v200, v204, s[68:69]
  v_cndmask_b32 v201, v201, v205, s[68:69]
  v_cndmask_b32 v202, v202, v206, s[68:69]
  v_cndmask_b32 v203, v203, v207, s[68:69]
  v_and_or_b32 v200, v200, -16, s80
  v_and_or_b32 v201, v201, -16, s81
  v_and_or_b32 v202, v202, -16, s82
  v_and_or_b32 v203, v203, -16, s83
  buffer_store_dwordx4 v[200:203], v42, s[48:51], s73 offen sc1
  s_mov_b64 exec, -1
  s_branch L_fin
L_stage3:
  s_sub_u32 s66, s86, 200
  s_cmp_ge_u32 s66, 40
  s_cbranch_scc1 L_fin
  s_cmp_ge_u32 s3, 2
  s_cbranch_scc1 L_fin
  s_and_b32 s74, s3, 1
  s_lshr_b32 s69, s66, 3
  s_bfe_u32 s67, s66, 0x10002
  s_and_b32 s68, s66, 2
  s_add_u32 s67, s67, s68
  s_lshl_b32 s71, s68, 1
  s_and_b32 s68, s66, 1
  s_lshl_b32 s68, s68, 1
  s_add_u32 s68, s68, s74
  s_lshl_b32 s66, s66, 2
  s_add_u32 s66, s66, s3
  s_add_u32 s66, s66, s74
  s_add_u32 s65, s71, s68
  s_xor_b32 s71, s67, s14
  s_and_b32 s71, s71, 1
  s_lshl_b32 s71, s71, 13
  s_mul_i32 s70, s69, 81920
  s_add_u32 s70, s70, s71
  s_add_u32 s70, s70, 1572864
  v_lshrrev_b32 v9, 3, v4
  v_and_b32 v10, 7, v4
  v_add_u32 v7, s65, v9
  v_and_b32 v7, 7, v7
  v_lshlrev_b32 v16, 10, v9
  v_lshl_add_u32 v16, v7, 7, v16
  v_lshl_add_u32 v16, v10, 4, v16
  s_add_u32 s71, s70, 16384
  s_add_u32 s72, s70, 32768
  s_add_u32 s73, s70, 49152
  s_add_u32 s74, s70, 65536
  s_lshl_b32 s69, s69, 2
  s_add_u32 s68, s68, s69
  v_bfe_u32 v7, v4, 4, 1
  v_bfe_u32 v8, v4, 5, 1
  v_lshl_add_u32 v7, v7, 1, v8
  v_lshl_add_u32 v7, v10, 2, v7
  v_lshlrev_b32 v18, 1, v7
  s_mul_i32 s67, s67, 1280
  s_lshl_b32 s68, s68, 6
  s_add_u32 s75, s67, s68
  buffer_load_ushort v19, v18, s[44:47], s75 offen
  s_mov_b32 s54, 5120
  s_mov_b32 s55, 0x00020000
  buffer_load_dwordx4 v[96:99], v16, s[48:51], s74 offen sc1
  buffer_load_dwordx4 v[80:83], v16, s[48:51], s70 offen sc1
  buffer_load_dwordx4 v[84:87], v16, s[48:51], s71 offen sc1
  buffer_load_dwordx4 v[88:91], v16, s[48:51], s72 offen sc1
  buffer_load_dwordx4 v[92:95], v16, s[48:51], s73 offen sc1
L_ypoll:
  buffer_load_dwordx4 v[116:119], v16, s[48:51], s74 offen sc1
  buffer_load_dwordx4 v[100:103], v16, s[48:51], s70 offen sc1
  buffer_load_dwordx4 v[104:107], v16, s[48:51], s71 offen sc1
  buffer_load_dwordx4 v[108:111], v16, s[48:51], s72 offen sc1
  buffer_load_dwordx4 v[112:115], v16, s[48:51], s73 offen sc1
  s_waitcnt vmcnt(9)
  v_xor_b32 v160, s80, v96
  v_xor_b32 v161, s81, v97
  v_xor_b32 v162, s82, v98
  v_xor_b32 v163, s83, v99
  v_or_b32 v7, v160, v161
  v_or3_b32 v7, v162, v163, v7
  s_waitcnt vmcnt(8)
  v_xor_b32 v80, s80, v80
  v_xor_b32 v81, s81, v81
  v_xor_b32 v82, s82, v82
  v_xor_b32 v83, s83, v83
  v_or3_b32 v7, v80, v81, v7
  v_or3_b32 v7, v82, v83, v7
  s_waitcnt vmcnt(7)
  v_xor_b32 v84, s80, v84
  v_xor_b32 v85, s81, v85
  v_xor_b32 v86, s82, v86
  v_xor_b32 v87, s83, v87
  v_or3_b32 v7, v84, v85, v7
  v_or3_b32 v7, v86, v87, v7
  v_pk_add_f32 v[80:81], v[80:81], v[84:85]
  v_pk_add_f32 v[82:83], v[82:83], v[86:87]
  s_waitcnt vmcnt(6)
  v_xor_b32 v88, s80, v88
  v_xor_b32 v89, s81, v89
  v_xor_b32 v90, s82, v90
  v_xor_b32 v91, s83, v91
  v_or3_b32 v7, v88, v89, v7
  v_or3_b32 v7, v90, v91, v7
  v_pk_add_f32 v[80:81], v[80:81], v[88:89]
  v_pk_add_f32 v[82:83], v[82:83], v[90:91]
  s_waitcnt vmcnt(5)
  v_xor_b32 v92, s80, v92
  v_xor_b32 v93, s81, v93
  v_xor_b32 v94, s82, v94
  v_xor_b32 v95, s83, v95
  v_or3_b32 v7, v92, v93, v7
  v_or3_b32 v7, v94, v95, v7
  v_and_b32 v7, 15, v7
  v_cmp_ne_u32 vcc, 0, v7
  v_pk_add_f32 v[144:145], v[80:81], v[92:93]
  v_pk_add_f32 v[146:147], v[82:83], v[94:95]
  s_cbranch_vccz L_yok
  buffer_load_dwordx4 v[96:99], v16, s[48:51], s74 offen sc1
  buffer_load_dwordx4 v[80:83], v16, s[48:51], s70 offen sc1
  buffer_load_dwordx4 v[84:87], v16, s[48:51], s71 offen sc1
  buffer_load_dwordx4 v[88:91], v16, s[48:51], s72 offen sc1
  buffer_load_dwordx4 v[92:95], v16, s[48:51], s73 offen sc1
  s_waitcnt vmcnt(9)
  v_xor_b32 v160, s80, v116
  v_xor_b32 v161, s81, v117
  v_xor_b32 v162, s82, v118
  v_xor_b32 v163, s83, v119
  v_or_b32 v7, v160, v161
  v_or3_b32 v7, v162, v163, v7
  s_waitcnt vmcnt(8)
  v_xor_b32 v100, s80, v100
  v_xor_b32 v101, s81, v101
  v_xor_b32 v102, s82, v102
  v_xor_b32 v103, s83, v103
  v_or3_b32 v7, v100, v101, v7
  v_or3_b32 v7, v102, v103, v7
  s_waitcnt vmcnt(7)
  v_xor_b32 v104, s80, v104
  v_xor_b32 v105, s81, v105
  v_xor_b32 v106, s82, v106
  v_xor_b32 v107, s83, v107
  v_or3_b32 v7, v104, v105, v7
  v_or3_b32 v7, v106, v107, v7
  v_pk_add_f32 v[100:101], v[100:101], v[104:105]
  v_pk_add_f32 v[102:103], v[102:103], v[106:107]
  s_waitcnt vmcnt(6)
  v_xor_b32 v108, s80, v108
  v_xor_b32 v109, s81, v109
  v_xor_b32 v110, s82, v110
  v_xor_b32 v111, s83, v111
  v_or3_b32 v7, v108, v109, v7
  v_or3_b32 v7, v110, v111, v7
  v_pk_add_f32 v[100:101], v[100:101], v[108:109]
  v_pk_add_f32 v[102:103], v[102:103], v[110:111]
  s_waitcnt vmcnt(5)
  v_xor_b32 v112, s80, v112
  v_xor_b32 v113, s81, v113
  v_xor_b32 v114, s82, v114
  v_xor_b32 v115, s83, v115
  v_or3_b32 v7, v112, v113, v7
  v_or3_b32 v7, v114, v115, v7
  v_and_b32 v7, 15, v7
  v_cmp_ne_u32 vcc, 0, v7
  v_pk_add_f32 v[144:145], v[100:101], v[112:113]
  v_pk_add_f32 v[146:147], v[102:103], v[114:115]
  s_cbranch_vccz L_yok
  s_sub_u32 s77, s77, 1
  s_cbranch_scc0 L_ypoll
  s_branch L_end
L_yok:
  v_permlane32_swap_b32 v160, v161
  v_permlane32_swap_b32 v162, v163
  v_permlane32_swap_b32 v144, v145
  v_permlane32_swap_b32 v146, v147
  v_add_f32 v160, v160, v161
  v_add_f32 v162, v162, v163
  v_add_f32 v144, v144, v145
  v_add_f32 v146, v146, v147
  v_permlane16_swap_b32 v160, v162
  v_lshlrev_b32 v19, 16, v19
  v_add_f32 v160, v160, v162
  v_permlane16_swap_b32 v144, v146
  v_add_f32 v144, v144, v146
  v_add_f32_dpp v160, v160, v160 row_ror:8 row_mask:0xf bank_mask:0xf
  v_cvt_pk_bf16_f32 v9, v160, v160
  v_add_f32_dpp v144, v144, v144 row_ror:8 row_mask:0xf bank_mask:0xf
  v_and_b32 v160, 0xffff0000, v9
  v_mul_f32 v10, 0xbfb8aa3b, v160
  v_exp_f32 v10, v10
  v_cvt_pk_bf16_f32 v9, v144, v144
  v_add_f32 v10, 1.0, v10
  v_rcp_f32 v10, v10
  v_and_b32 v144, 0xffff0000, v9
  v_mul_f32 v160, v160, v10
  v_cvt_pk_bf16_f32 v9, v160, v160
  v_and_b32 v160, 0xffff0000, v9
  v_mul_f32 v144, v144, v160
  v_cvt_pk_bf16_f32 v9, v144, v144
  v_and_b32 v144, 0xffff0000, v9
  v_add_f32 v144, v19, v144
  s_mov_b32 exec_lo, 0x00ff00ff
  s_mov_b32 exec_hi, 0x00ff00ff
  v_cvt_pk_bf16_f32 v9, v144, v144
  buffer_store_short v9, v18, s[52:55], s75 offen sc1
  s_cmp_lg_u32 s66, 0
  s_cbranch_scc1 L_noe
  s_mov_b64 exec, 1
  v_mov_b32 v10, 0
  buffer_store_dword v17, v10, s[48:51], 0 offen sc1
L_noe:
  s_mov_b64 exec, -1
L_fin:
L_end:
  s_endpgm
L_probe:
  v_lshrrev_b32 v7, 1, v4
  v_mul_u32_u24 v7, 21376, v7
  v_and_b32 v7, 4294959103, v7
  v_and_b32 v8, 1, v4
  v_lshl_add_u32 v7, v8, 13, v7
  v_mov_b32 v8, 0
  s_mov_b32 s65, 524288
  s_mov_b64 exec, 63
  buffer_store_dword v8, v7, s[48:51], s65 offen sc1
  s_mov_b64 exec, -1
  s_mov_b32 s65, 0
  s_waitcnt vmcnt(0) lgkmcnt(0)
  s_mov_b32 s75, -1
  s_load_dword s74, s[24:25], 524288 glc
  s_load_dword s75, s[24:25], 532480 glc
  s_waitcnt lgkmcnt(1)
  s_cmp_eq_u32 s75, 0
  s_addc_u32 s65, s65, 0
  s_waitcnt lgkmcnt(0)
  s_mov_b32 s75, -1
  s_load_dword s74, s[24:25], 553856 glc
  s_load_dword s75, s[24:25], 545664 glc
  s_waitcnt lgkmcnt(1)
  s_cmp_lg_u32 s75, 0
  s_addc_u32 s65, s65, 0
  s_waitcnt lgkmcnt(0)
  s_mov_b32 s75, -1
  s_load_dword s74, s[24:25], 558848 glc
  s_load_dword s75, s[24:25], 567040 glc
  s_waitcnt lgkmcnt(1)
  s_cmp_eq_u32 s75, 0
  s_addc_u32 s65, s65, 0
  s_waitcnt lgkmcnt(0)
  s_lshr_b32 s65, s65, 1
  s_bfe_u32 s67, s2, 0x10002
  s_xor_b32 s14, s65, s67
  s_branch L_probed
L_g4:
  s_waitcnt vmcnt(2)
  buffer_load_dwordx4 v[144:147], v231, s[48:51], s88 offen sc1
  buffer_load_dwordx4 v[148:151], v231, s[48:51], s89 offen sc1
  buffer_load_dwordx4 v[152:155], v231, s[48:51], s90 offen sc1
  buffer_load_dwordx4 v[156:159], v231, s[48:51], s91 offen sc1
  s_waitcnt vmcnt(3)
  v_xor_b32 v144, s80, v144
  v_xor_b32 v145, s81, v145
  v_xor_b32 v146, s82, v146
  v_xor_b32 v147, s83, v147
  v_or_b32 v7, v144, v145
  v_or3_b32 v7, v146, v147, v7
  s_waitcnt vmcnt(2)
  v_xor_b32 v148, s80, v148
  v_xor_b32 v149, s81, v149
  v_xor_b32 v150, s82, v150
  v_xor_b32 v151, s83, v151
  v_or3_b32 v7, v148, v149, v7
  v_or3_b32 v7, v150, v151, v7
  v_pk_add_f32 v[144:145], v[144:145], v[148:149]
  v_pk_add_f32 v[146:147], v[146:147], v[150:151]
  s_waitcnt vmcnt(1)
  v_xor_b32 v152, s80, v152
  v_xor_b32 v153, s81, v153
  v_xor_b32 v154, s82, v154
  v_xor_b32 v155, s83, v155
  v_or3_b32 v7, v152, v153, v7
  v_or3_b32 v7, v154, v155, v7
  v_pk_add_f32 v[144:145], v[144:145], v[152:153]
  v_pk_add_f32 v[146:147], v[146:147], v[154:155]
  s_waitcnt vmcnt(0)
  v_xor_b32 v156, s80, v156
  v_xor_b32 v157, s81, v157
  v_xor_b32 v158, s82, v158
  v_xor_b32 v159, s83, v159
  v_or3_b32 v7, v156, v157, v7
  v_or3_b32 v7, v158, v159, v7
  v_pk_add_f32 v[144:145], v[144:145], v[156:157]
  v_pk_add_f32 v[146:147], v[146:147], v[158:159]
  v_and_b32 v7, 15, v7
  v_cmp_ne_u32 vcc, 0, v7
  v_cvt_pk_bf16_f32 v20, v144, v145
  v_cvt_pk_bf16_f32 v21, v146, v147
  s_cbranch_vccz L_ook
L_gl4:
  buffer_load_dwordx4 v[144:147], v231, s[48:51], s88 offen sc1
  buffer_load_dwordx4 v[148:151], v231, s[48:51], s89 offen sc1
  buffer_load_dwordx4 v[152:155], v231, s[48:51], s90 offen sc1
  buffer_load_dwordx4 v[156:159], v231, s[48:51], s91 offen sc1
  s_waitcnt vmcnt(3)
  v_xor_b32 v144, s80, v144
  v_xor_b32 v145, s81, v145
  v_xor_b32 v146, s82, v146
  v_xor_b32 v147, s83, v147
  v_or_b32 v7, v144, v145
  v_or3_b32 v7, v146, v147, v7
  s_waitcnt vmcnt(2)
  v_xor_b32 v148, s80, v148
  v_xor_b32 v149, s81, v149
  v_xor_b32 v150, s82, v150
  v_xor_b32 v151, s83, v151
  v_or3_b32 v7, v148, v149, v7
  v_or3_b32 v7, v150, v151, v7
  v_pk_add_f32 v[144:145], v[144:145], v[148:149]
  v_pk_add_f32 v[146:147], v[146:147], v[150:151]
  s_waitcnt vmcnt(1)
  v_xor_b32 v152, s80, v152
  v_xor_b32 v153, s81, v153
  v_xor_b32 v154, s82, v154
  v_xor_b32 v155, s83, v155
  v_or3_b32 v7, v152, v153, v7
  v_or3_b32 v7, v154, v155, v7
  v_pk_add_f32 v[144:145], v[144:145], v[152:153]
  v_pk_add_f32 v[146:147], v[146:147], v[154:155]
  s_waitcnt vmcnt(0)
  v_xor_b32 v156, s80, v156
  v_xor_b32 v157, s81, v157
  v_xor_b32 v158, s82, v158
  v_xor_b32 v159, s83, v159
  v_or3_b32 v7, v156, v157, v7
  v_or3_b32 v7, v158, v159, v7
  v_pk_add_f32 v[144:145], v[144:145], v[156:157]
  v_pk_add_f32 v[146:147], v[146:147], v[158:159]
  v_and_b32 v7, 15, v7
  v_cmp_ne_u32 vcc, 0, v7
  v_cvt_pk_bf16_f32 v20, v144, v145
  v_cvt_pk_bf16_f32 v21, v146, v147
  s_cbranch_vccz L_ook
  s_sub_u32 s77, s77, 1
  s_cbranch_scc0 L_gl4
  s_branch L_end
L_g8:
  s_waitcnt vmcnt(2)
  buffer_load_dwordx4 v[144:147], v231, s[48:51], s88 offen sc1
  buffer_load_dwordx4 v[148:151], v231, s[48:51], s89 offen sc1
  buffer_load_dwordx4 v[152:155], v231, s[48:51], s90 offen sc1
  buffer_load_dwordx4 v[156:159], v231, s[48:51], s91 offen sc1
  buffer_load_dwordx4 v[160:163], v231, s[48:51], s92 offen sc1
  buffer_load_dwordx4 v[164:167], v231, s[48:51], s93 offen sc1
  buffer_load_dwordx4 v[168:171], v231, s[48:51], s94 offen sc1
  buffer_load_dwordx4 v[172:175], v231, s[48:51], s95 offen sc1
  s_waitcnt vmcnt(7)
  v_xor_b32 v144, s80, v144
  v_xor_b32 v145, s81, v145
  v_xor_b32 v146, s82, v146
  v_xor_b32 v147, s83, v147
  v_or_b32 v7, v144, v145
  v_or3_b32 v7, v146, v147, v7
  s_waitcnt vmcnt(6)
  v_xor_b32 v148, s80, v148
  v_xor_b32 v149, s81, v149
  v_xor_b32 v150, s82, v150
  v_xor_b32 v151, s83, v151
  v_or3_b32 v7, v148, v149, v7
  v_or3_b32 v7, v150, v151, v7
  v_pk_add_f32 v[144:145], v[144:145], v[148:149]
  v_pk_add_f32 v[146:147], v[146:147], v[150:151]
  s_waitcnt vmcnt(5)
  v_xor_b32 v152, s80, v152
  v_xor_b32 v153, s81, v153
  v_xor_b32 v154, s82, v154
  v_xor_b32 v155, s83, v155
  v_or3_b32 v7, v152, v153, v7
  v_or3_b32 v7, v154, v155, v7
  v_pk_add_f32 v[144:145], v[144:145], v[152:153]
  v_pk_add_f32 v[146:147], v[146:147], v[154:155]
  s_waitcnt vmcnt(4)
  v_xor_b32 v156, s80, v156
  v_xor_b32 v157, s81, v157
  v_xor_b32 v158, s82, v158
  v_xor_b32 v159, s83, v159
  v_or3_b32 v7, v156, v157, v7
  v_or3_b32 v7, v158, v159, v7
  v_pk_add_f32 v[144:145], v[144:145], v[156:157]
  v_pk_add_f32 v[146:147], v[146:147], v[158:159]
  s_waitcnt vmcnt(3)
  v_xor_b32 v160, s80, v160
  v_xor_b32 v161, s81, v161
  v_xor_b32 v162, s82, v162
  v_xor_b32 v163, s83, v163
  v_or3_b32 v7, v160, v161, v7
  v_or3_b32 v7, v162, v163, v7
  v_pk_add_f32 v[144:145], v[144:145], v[160:161]
  v_pk_add_f32 v[146:147], v[146:147], v[162:163]
  s_waitcnt vmcnt(2)
  v_xor_b32 v164, s80, v164
  v_xor_b32 v165, s81, v165
  v_xor_b32 v166, s82, v166
  v_xor_b32 v167, s83, v167
  v_or3_b32 v7, v164, v165, v7
  v_or3_b32 v7, v166, v167, v7
  v_pk_add_f32 v[144:145], v[144:145], v[164:165]
  v_pk_add_f32 v[146:147], v[146:147], v[166:167]
  s_waitcnt vmcnt(1)
  v_xor_b32 v168, s80, v168
  v_xor_b32 v169, s81, v169
  v_xor_b32 v170, s82, v170
  v_xor_b32 v171, s83, v171
  v_or3_b32 v7, v168, v169, v7
  v_or3_b32 v7, v170, v171, v7
  v_pk_add_f32 v[144:145], v[144:145], v[168:169]
  v_pk_add_f32 v[146:147], v[146:147], v[170:171]
  s_waitcnt vmcnt(0)
  v_xor_b32 v172, s80, v172
  v_xor_b32 v173, s81, v173
  v_xor_b32 v174, s82, v174
  v_xor_b32 v175, s83, v175
  v_or3_b32 v7, v172, v173, v7
  v_or3_b32 v7, v174, v175, v7
  v_pk_add_f32 v[144:145], v[144:145], v[172:173]
  v_pk_add_f32 v[146:147], v[146:147], v[174:175]
  v_and_b32 v7, 15, v7
  v_cmp_ne_u32 vcc, 0, v7
  v_cvt_pk_bf16_f32 v20, v144, v145
  v_cvt_pk_bf16_f32 v21, v146, v147
  s_cbranch_vccz L_ook
L_gl8:
  buffer_load_dwordx4 v[144:147], v231, s[48:51], s88 offen sc1
  buffer_load_dwordx4 v[148:151], v231, s[48:51], s89 offen sc1
  buffer_load_dwordx4 v[152:155], v231, s[48:51], s90 offen sc1
  buffer_load_dwordx4 v[156:159], v231, s[48:51], s91 offen sc1
  buffer_load_dwordx4 v[160:163], v231, s[48:51], s92 offen sc1
  buffer_load_dwordx4 v[164:167], v231, s[48:51], s93 offen sc1
  buffer_load_dwordx4 v[168:171], v231, s[48:51], s94 offen sc1
  buffer_load_dwordx4 v[172:175], v231, s[48:51], s95 offen sc1
  s_waitcnt vmcnt(7)
  v_xor_b32 v144, s80, v144
  v_xor_b32 v145, s81, v145
  v_xor_b32 v146, s82, v146
  v_xor_b32 v147, s83, v147
  v_or_b32 v7, v144, v145
  v_or3_b32 v7, v146, v147, v7
  s_waitcnt vmcnt(6)
  v_xor_b32 v148, s80, v148
  v_xor_b32 v149, s81, v149
  v_xor_b32 v150, s82, v150
  v_xor_b32 v151, s83, v151
  v_or3_b32 v7, v148, v149, v7
  v_or3_b32 v7, v150, v151, v7
  v_pk_add_f32 v[144:145], v[144:145], v[148:149]
  v_pk_add_f32 v[146:147], v[146:147], v[150:151]
  s_waitcnt vmcnt(5)
  v_xor_b32 v152, s80, v152
  v_xor_b32 v153, s81, v153
  v_xor_b32 v154, s82, v154
  v_xor_b32 v155, s83, v155
  v_or3_b32 v7, v152, v153, v7
  v_or3_b32 v7, v154, v155, v7
  v_pk_add_f32 v[144:145], v[144:145], v[152:153]
  v_pk_add_f32 v[146:147], v[146:147], v[154:155]
  s_waitcnt vmcnt(4)
  v_xor_b32 v156, s80, v156
  v_xor_b32 v157, s81, v157
  v_xor_b32 v158, s82, v158
  v_xor_b32 v159, s83, v159
  v_or3_b32 v7, v156, v157, v7
  v_or3_b32 v7, v158, v159, v7
  v_pk_add_f32 v[144:145], v[144:145], v[156:157]
  v_pk_add_f32 v[146:147], v[146:147], v[158:159]
  s_waitcnt vmcnt(3)
  v_xor_b32 v160, s80, v160
  v_xor_b32 v161, s81, v161
  v_xor_b32 v162, s82, v162
  v_xor_b32 v163, s83, v163
  v_or3_b32 v7, v160, v161, v7
  v_or3_b32 v7, v162, v163, v7
  v_pk_add_f32 v[144:145], v[144:145], v[160:161]
  v_pk_add_f32 v[146:147], v[146:147], v[162:163]
  s_waitcnt vmcnt(2)
  v_xor_b32 v164, s80, v164
  v_xor_b32 v165, s81, v165
  v_xor_b32 v166, s82, v166
  v_xor_b32 v167, s83, v167
  v_or3_b32 v7, v164, v165, v7
  v_or3_b32 v7, v166, v167, v7
  v_pk_add_f32 v[144:145], v[144:145], v[164:165]
  v_pk_add_f32 v[146:147], v[146:147], v[166:167]
  s_waitcnt vmcnt(1)
  v_xor_b32 v168, s80, v168
  v_xor_b32 v169, s81, v169
  v_xor_b32 v170, s82, v170
  v_xor_b32 v171, s83, v171
  v_or3_b32 v7, v168, v169, v7
  v_or3_b32 v7, v170, v171, v7
  v_pk_add_f32 v[144:145], v[144:145], v[168:169]
  v_pk_add_f32 v[146:147], v[146:147], v[170:171]
  s_waitcnt vmcnt(0)
  v_xor_b32 v172, s80, v172
  v_xor_b32 v173, s81, v173
  v_xor_b32 v174, s82, v174
  v_xor_b32 v175, s83, v175
  v_or3_b32 v7, v172, v173, v7
  v_or3_b32 v7, v174, v175, v7
  v_pk_add_f32 v[144:145], v[144:145], v[172:173]
  v_pk_add_f32 v[146:147], v[146:147], v[174:175]
  v_and_b32 v7, 15, v7
  v_cmp_ne_u32 vcc, 0, v7
  v_cvt_pk_bf16_f32 v20, v144, v145
  v_cvt_pk_bf16_f32 v21, v146, v147
  s_cbranch_vccz L_ook
  s_sub_u32 s77, s77, 1
  s_cbranch_scc0 L_gl8
  s_branch L_end
H_K:
  s_cmp_lt_u32 s94, 2
  s_cbranch_scc1 H_K1
  s_add_u32 s69, s95, -2
  s_mul_i32 s69, s69, 10
  s_lshr_b32 s72, s20, s69
  s_bfe_u32 s69, s72, 0x70003
  s_mul_i32 s70, s69, 896
  s_add_u32 s70, s70, 4096
  s_add_u32 s72, s69, 1
  s_and_b32 s72, s72, 2
  s_lshl_b32 s72, s72, 1
  s_add_u32 s72, s72, 4
  s_cmp_ge_u32 s69, 86
  s_cselect_b32 s72, 6, s72
  s_bfm_b32 s17, s72, 0
  s_mul_i32 s17, s17, 0x10001
  s_sub_u32 s72, s72, 1
  s_mov_b32 exec_lo, 0x7fff7fff
  s_mov_b32 exec_hi, 0x7fff7fff
  v_min_u32 v232, s72, v40
  v_lshl_add_u32 v232, v232, 4, s70
  s_mov_b64 exec, -1
  buffer_load_dwordx4 v[32:35], v232, s[48:51], 0 offen sc1
  s_movk_i32 s93, 0x7fff
  s_setpc_b64 s[26:27]
H_K1:
  v_add_u32 v42, 384, v42
  ds_read_b128 v[44:47], v42 offset:0
  ds_read_b128 v[48:51], v42 offset:128
  ds_read_b128 v[52:55], v42 offset:256
  s_cmp_eq_u32 s94, 0
  s_cselect_b32 s93, s92, 120
  s_add_u32 s94, s94, 1
H_KS:
  v_mov_b32 v9, v5
  s_nop 1
  v_max_f32_dpp v9, v9, v9 row_half_mirror row_mask:0xf bank_mask:0xf
  s_nop 1
  v_max_f32_dpp v9, v9, v9 row_ror:8 row_mask:0xf bank_mask:0xf
  v_mov_b32 v10, v9
  s_nop 1
  v_permlane16_swap_b32 v9, v10
  s_nop 0
  v_max_f32 v9, v9, v10
  v_mov_b32 v10, v9
  s_nop 1
  v_permlane32_swap_b32 v9, v10
  s_nop 0
  v_max_f32 v9, v9, v10
  v_sub_f32 v5, v5, v9
  v_mul_f32 v5, 0x3fb8aa3b, v5
  v_exp_f32 v5, v5
  s_mov_b32 s66, s95
  v_mul_f32 v6, v6, v5
  s_nop 1
  v_add_f32_dpp v6, v6, v6 row_half_mirror row_mask:0xf bank_mask:0xf
  s_nop 1
  v_add_f32_dpp v6, v6, v6 row_ror:8 row_mask:0xf bank_mask:0xf
  v_mov_b32 v10, v6
  s_nop 1
  v_permlane16_swap_b32 v6, v10
  s_nop 0
  v_add_f32 v6, v6, v10
  v_mov_b32 v10, v6
  s_nop 1
  v_permlane32_swap_b32 v6, v10
  s_nop 0
  v_add_f32 v6, v6, v10
  s_lshl_b32 s67, s66, 5
  s_add_u32 s67, s67, 70800
  s_lshl_b32 s68, s3, 3
  s_add_u32 s68, s68, s67
  s_lshl_b32 s66, s66, 2
  s_add_u32 s66, s66, 70784
  v_mov_b32 v8, s68
  v_mov_b32 v7, s66
  v_mov_b32 v10, 1
  s_mov_b64 exec, 1
  ds_write2_b32 v8, v9, v6 offset0:0 offset1:1
  ds_add_rtn_u32 v10, v7, v10
  s_mov_b64 exec, -1
  s_add_u32 s69, s95, 0
  s_mul_i32 s69, s69, 10
  s_lshr_b32 s72, s20, s69
  s_bfe_u32 s69, s72, 0x70003
  s_mul_i32 s70, s69, 896
  s_and_b32 s72, s72, 7
  s_lshl_b32 s72, s72, 4
  s_add_u32 s70, s70, s72
  s_add_u32 s70, s70, 4096
  s_add_u32 s95, s95, 1
  s_waitcnt lgkmcnt(0)
  v_readfirstlane_b32 s68, v10
  v_mov_b32 v6, 0
  v_mov_b32 v5, 0xff7f0000
  s_nop 1
  s_cmp_lg_u32 s68, 3
  s_cbranch_scc1 H_KS1
  s_cmp_ge_u32 s95, 3
  s_cbranch_scc1 H_KS1
H_KS0:
  v_and_b32 v9, 3, v4
  v_lshl_add_u32 v10, v9, 3, s67
  ds_read_b64 v[24:25], v10
  v_mov_b32 v21, v17
  v_mov_b32 v23, v17
  v_mov_b32 v9, 0
  s_waitcnt lgkmcnt(0)
  v_mov_b32 v20, v24
  s_nop 1
  v_max_f32_dpp v20, v20, v20 quad_perm:[1,0,3,2] row_mask:0xf bank_mask:0xf
  s_nop 1
  v_max_f32_dpp v20, v20, v20 quad_perm:[2,3,0,1] row_mask:0xf bank_mask:0xf
  v_sub_f32 v10, v24, v20
  v_mul_f32 v10, 0x3fb8aa3b, v10
  v_exp_f32 v10, v10
  s_nop 0
  v_mul_f32 v22, v10, v25
  s_nop 1
  v_add_f32_dpp v22, v22, v22 quad_perm:[1,0,3,2] row_mask:0xf bank_mask:0xf
  s_nop 1
  v_add_f32_dpp v22, v22, v22 quad_perm:[2,3,0,1] row_mask:0xf bank_mask:0xf
  s_mov_b64 exec, 1
  buffer_store_dwordx4 v[20:23], v9, s[48:51], s70 offen sc1
  s_mov_b64 exec, -1
H_KS1:
  s_setpc_b64 s[26:27]
H_V:
  s_cmp_lg_i32 s94, -1
  s_cbranch_scc1 H_V0
  s_mov_b32 s94, 0
  s_sub_u32 s93, s91, 8
  s_cmp_lg_u32 s3, 3
  s_cbranch_scc1 H_KS1
  s_mov_b32 s67, 70864
  s_add_u32 s69, s95, 2
  s_mul_i32 s69, s69, 10
  s_lshr_b32 s72, s20, s69
  s_bfe_u32 s69, s72, 0x70003
  s_mul_i32 s70, s69, 896
  s_and_b32 s72, s72, 7
  s_lshl_b32 s72, s72, 4
  s_add_u32 s70, s70, s72
  s_add_u32 s70, s70, 4096
  s_branch H_KS0
H_V0:
  s_bitcmp1_b32 s94, 0
  s_cbranch_scc1 H_V1
  s_add_u32 s69, s95, 1
  s_mul_i32 s69, s69, 10
  s_lshr_b32 s72, s20, s69
  s_bfe_u32 s69, s72, 0x70003
  s_mul_i32 s70, s69, 896
  s_add_u32 s70, s70, 4096
  s_add_u32 s72, s69, 1
  s_and_b32 s72, s72, 2
  s_lshl_b32 s72, s72, 1
  s_add_u32 s72, s72, 4
  s_cmp_ge_u32 s69, 86
  s_cselect_b32 s72, 6, s72
  s_bfm_b32 s17, s72, 0
  s_mul_i32 s17, s17, 0x10001
  s_sub_u32 s72, s72, 1
  s_mov_b32 exec_lo, 0x7fff7fff
  s_mov_b32 exec_hi, 0x7fff7fff
  v_min_u32 v232, s72, v40
  v_lshl_add_u32 v232, v232, 4, s70
  s_mov_b64 exec, -1
  buffer_load_dwordx4 v[32:35], v232, s[48:51], 0 offen sc1
  s_add_u32 s93, s93, 8
  s_add_u32 s94, s94, 1
  s_setpc_b64 s[26:27]
H_V1:
  v_permlane32_swap_b32 v56, v60
  v_permlane32_swap_b32 v57, v61
  v_permlane32_swap_b32 v58, v62
  v_permlane32_swap_b32 v59, v63
  v_permlane32_swap_b32 v64, v68
  v_permlane32_swap_b32 v65, v69
  v_permlane32_swap_b32 v66, v70
  v_permlane32_swap_b32 v67, v71
  v_permlane32_swap_b32 v72, v76
  v_permlane32_swap_b32 v73, v77
  v_permlane32_swap_b32 v74, v78
  v_permlane32_swap_b32 v75, v79
  v_add_f32 v56, v56, v60
  v_add_f32 v57, v57, v61
  v_add_f32 v58, v58, v62
  v_add_f32 v59, v59, v63
  v_add_f32 v64, v64, v68
  v_add_f32 v65, v65, v69
  v_add_f32 v66, v66, v70
  v_add_f32 v67, v67, v71
  v_add_f32 v72, v72, v76
  v_add_f32 v73, v73, v77
  v_add_f32 v74, v74, v78
  v_add_f32 v75, v75, v79
  v_permlane16_swap_b32 v56, v58
  v_permlane16_swap_b32 v57, v59
  v_permlane16_swap_b32 v64, v66
  v_permlane16_swap_b32 v65, v67
  v_permlane16_swap_b32 v72, v74
  v_permlane16_swap_b32 v73, v75
  v_add_f32 v56, v56, v58
  v_add_f32 v57, v57, v59
  v_add_f32 v64, v64, v66
  v_add_f32 v65, v65, v67
  v_add_f32 v72, v72, v74
  v_add_f32 v73, v73, v75
  v_add_f32_dpp v58, v56, v56 row_ror:8 row_mask:0xf bank_mask:0x3
  v_add_f32_dpp v58, v57, v57 row_ror:8 row_mask:0xf bank_mask:0xc
  v_add_f32_dpp v66, v64, v64 row_ror:8 row_mask:0xf bank_mask:0x3
  v_add_f32_dpp v66, v65, v65 row_ror:8 row_mask:0xf bank_mask:0xc
  v_add_f32_dpp v74, v72, v72 row_ror:8 row_mask:0xf bank_mask:0x3
  v_add_f32_dpp v74, v73, v73 row_ror:8 row_mask:0xf bank_mask:0xc
  ds_write_b32 v41, v58 offset:0
  ds_write_b32 v41, v66 offset:256
  ds_write_b32 v41, v74 offset:512
  v_add_u32 v41, 3072, v41
  s_waitcnt lgkmcnt(0)
  v_mov_b32 v56, 0
  v_mov_b32 v57, 0
  v_mov_b32 v58, 0
  v_mov_b32 v59, 0
  v_mov_b32 v60, 0
  v_mov_b32 v61, 0
  v_mov_b32 v62, 0
  v_mov_b32 v63, 0
  v_mov_b32 v64, 0
  v_mov_b32 v65, 0
  v_mov_b32 v66, 0
  v_mov_b32 v67, 0
  v_mov_b32 v68, 0
  v_mov_b32 v69, 0
  v_mov_b32 v70, 0
  v_mov_b32 v71, 0
  v_mov_b32 v72, 0
  v_mov_b32 v73, 0
  v_mov_b32 v74, 0
  v_mov_b32 v75, 0
  v_mov_b32 v76, 0
  v_mov_b32 v77, 0
  v_mov_b32 v78, 0
  v_mov_b32 v79, 0
  s_add_u32 s95, s95, 1
  s_sub_u32 s66, s92, 8
  s_cmp_eq_u32 s94, 1
  s_cselect_b32 s93, s66, 0x7fff
  s_add_u32 s94, s94, 1
H_VS:
  v_xor_b32 v7, v33, v17
  v_bitop3_b32 v7, v35, v17, v7 bitop3:0xbe
  v_cmp_ne_u32 vcc, 0, v7
  s_nop 1
  s_cbranch_vccz H_VS1
  s_sub_u32 s77, s77, 1
  s_cbranch_scc1 L_end
  s_add_u32 s69, s95, 0
  s_mul_i32 s69, s69, 10
  s_lshr_b32 s72, s20, s69
  s_bfe_u32 s69, s72, 0x70003
  s_mul_i32 s70, s69, 896
  s_add_u32 s70, s70, 4096
  s_add_u32 s72, s69, 1
  s_and_b32 s72, s72, 2
  s_lshl_b32 s72, s72, 1
  s_add_u32 s72, s72, 4
  s_cmp_ge_u32 s69, 86
  s_cselect_b32 s72, 6, s72
  s_bfm_b32 s17, s72, 0
  s_mul_i32 s17, s17, 0x10001
  s_sub_u32 s72, s72, 1
  s_mov_b32 exec_lo, 0x7fff7fff
  s_mov_b32 exec_hi, 0x7fff7fff
  v_min_u32 v232, s72, v40
  v_lshl_add_u32 v232, v232, 4, s70
  s_mov_b64 exec, -1
  buffer_load_dwordx4 v[32:35], v232, s[48:51], 0 offen sc1
  s_waitcnt vmcnt(0)
  s_branch H_VS
H_VS1:
  v_readlane_b32 s14, v34, 15
  v_mov_b32 v5, 0xff7f0000
  v_mov_b32 v6, 0
  s_mov_b32 exec_lo, s17
  s_mov_b32 exec_hi, s17
  v_mov_b32 v5, v32
  s_mov_b64 exec, -1
  s_nop 1
  v_max_f32_dpp v5, v5, v5 quad_perm:[1,0,3,2] row_mask:0xf bank_mask:0xf
  s_nop 1
  v_max_f32_dpp v5, v5, v5 quad_perm:[2,3,0,1] row_mask:0xf bank_mask:0xf
  s_nop 1
  v_max_f32_dpp v5, v5, v5 row_half_mirror row_mask:0xf bank_mask:0xf
  s_nop 1
  v_max_f32_dpp v5, v5, v5 row_mirror row_mask:0xf bank_mask:0xf
  s_mov_b32 exec_lo, s17
  s_mov_b32 exec_hi, s17
  v_sub_f32 v9, v32, v5
  v_mul_f32 v9, 0x3fb8aa3b, v9
  v_exp_f32 v9, v9
  s_nop 0
  v_mul_f32 v6, v9, v34
  s_mov_b64 exec, -1
  s_nop 1
  v_add_f32_dpp v6, v6, v6 quad_perm:[1,0,3,2] row_mask:0xf bank_mask:0xf
  s_nop 1
  v_add_f32_dpp v6, v6, v6 quad_perm:[2,3,0,1] row_mask:0xf bank_mask:0xf
  s_nop 1
  v_add_f32_dpp v6, v6, v6 row_half_mirror row_mask:0xf bank_mask:0xf
  s_nop 1
  v_add_f32_dpp v6, v6, v6 row_mirror row_mask:0xf bank_mask:0xf
  v_rcp_f32 v9, v6
  s_nop 0
  v_fma_f32 v10, -v6, v9, 1.0
  v_fma_f32 v6, v10, v9, v9
  s_setpc_b64 s[26:27]
.section .rodata,"a"
.p2align 6
.amdhsa_kernel recurrent_scan__mha_block_cached__dense_activation_relu__decode_kernel
  .amdhsa_next_free_vgpr 236
  .amdhsa_next_free_sgpr 102
  .amdhsa_accum_offset 236
  .amdhsa_group_segment_fixed_size 0
  .amdhsa_kernarg_size 88
  .amdhsa_user_sgpr_count 2
  .amdhsa_user_sgpr_kernarg_segment_ptr 1
  .amdhsa_system_sgpr_workgroup_id_x 1
  .amdhsa_float_denorm_mode_32 3
.end_amdhsa_kernel
```
